```python
import torch

def _softmax(x, axis=-1):
    return torch.softmax(x, dim=axis)
def _gelu(x):
    return torch.nn.functional.gelu(x, approximate="tanh")
def _silu(x):
    return torch.nn.functional.silu(x)
def _sigmoid(x):
    return torch.sigmoid(x)
def _layernorm(x, axis=-1, eps=1e-5):
    m = x.mean(dim=axis, keepdim=True)
    v = x.var(dim=axis, keepdim=True, unbiased=False)
    return (x - m) / torch.sqrt(v + eps)
def _scatter_add(tgt, idx, src, axis=0):
    return tgt.clone().index_add_(axis, idx, src)
def _segment_sum(src, seg, n):
    out = torch.zeros((n,) + src.shape[1:], dtype=src.dtype)
    return out.index_add_(0, seg, src)
def _pad(x, pw):
    flat = tuple(v for pair in reversed(pw) for v in pair)
    return torch.nn.functional.pad(x, flat)

kernel_name = 'standalone__gqa_softmax__sampling'

def setup_inputs():

    _w = (lambda a: (lambda t: t.to(torch.bfloat16) if t.is_floating_point() else t)(torch.as_tensor(a)))
    B, Hq, Hkv, Sq, Sk, D = 16, 32, 8, 16, 2048, 128
    return {
        "q": _w((lambda *s: torch.randn(*s, dtype=torch.bfloat16) * 0.8)(B, Hq, Sq, D)),
        "k": _w((lambda *s: torch.randn(*s, dtype=torch.bfloat16) * 0.8)(B, Hkv, Sk, D)),
        "v": _w((lambda *s: torch.randn(*s, dtype=torch.bfloat16) * 0.05)(B, Hkv, Sk, D)),
    }

def reference(q, k, v):
    B, Hq, Sq, D = q.shape
    Hkv = k.shape[1]
    rep = Hq // Hkv
    k = (lambda x, n, axis: torch.repeat_interleave(x, n, dim=axis))(k, rep, axis=1)
    v = (lambda x, n, axis: torch.repeat_interleave(x, n, dim=axis))(v, rep, axis=1)
    scale = D ** -0.5
    scores = torch.einsum("bhqd,bhkd->bhqk", q, k) * scale
    p = _softmax(scores, axis=-1)
    return torch.einsum("bhqk,bhkd->bhqd", p, v)
```

```asm
; @launch grid=(256,1,1) block=(512,1,1) lds=147456
.amdgcn_target "amdgcn-amd-amdhsa--gfx950"
.text
.globl standalone__gqa_softmax__sampling_kernel
.p2align 8
.type standalone__gqa_softmax__sampling_kernel,@function
standalone__gqa_softmax__sampling_kernel:
    s_getpc_b64 s[48:49]
    s_load_dwordx8 s[64:71], s[0:1], 0
    s_cmp_ge_u32 s2, 256
    s_cbranch_scc1 L_end
    s_cmp_ge_u32 s2, 32
    s_cbranch_scc1 L_nopf0
    v_lshlrev_b32 v220, 7, v0
    v_cmp_gt_u32 vcc, L_end-standalone__gqa_softmax__sampling_kernel-8, v220
    s_and_saveexec_b64 s[52:53], vcc
    s_cbranch_execz L_pfx0
    global_load_dword v221, v220, s[48:49]
L_pfx0:
    s_mov_b64 exec, -1
L_nopf0:
    v_lshrrev_b32 v1, 6, v0
    v_and_b32 v2, 63, v0
    s_lshr_b32 s21, s2, 4
    v_readfirstlane_b32 s3, v1
    s_and_b32 s22, s2, 7
    s_lshl_b32 s22, s22, 2
    s_and_b32 s23, s21, 3
    s_or_b32 s22, s22, s23
    s_lshr_b32 s21, s21, 2
    s_lshl_b32 s21, s21, 5
    s_or_b32 s21, s21, s22
    s_bfe_u32 s22, s2, 0x10003
    v_and_b32 v3, 15, v2
    v_lshrrev_b32 v4, 4, v2
    v_xor_b32 v6, v3, v4
    s_cmp_ge_u32 s3, 4
    s_cbranch_scc1 L_compute
    s_lshl_b32 s20, s21, 19
    s_lshl_b32 s26, s3, 12
    v_lshlrev_b32 v5, 8, v4
    v_xor_b32 v7, 0, v6
    v_lshl_add_u32 v8, v7, 4, v5
    v_xor_b32 v7, 4, v6
    v_lshl_add_u32 v9, v7, 4, v5
    v_xor_b32 v7, 8, v6
    v_lshl_add_u32 v10, v7, 4, v5
    v_xor_b32 v7, 12, v6
    v_lshl_add_u32 v11, v7, 4, v5
    s_lshl_b32 s24, s21, 14
    s_add_u32 s20, s20, s26
    s_add_u32 s24, s24, s26
    s_mov_b32 s11, 0x20000
    s_mov_b32 s15, 0x20000
    s_mov_b32 s39, 0x20000
    s_mov_b32 s38, 4096
    s_sub_u32 s10, 0x80000, s26
    s_mov_b32 s14, s10
    s_add_u32 m0, s26, 131072
    s_waitcnt lgkmcnt(0)
    s_add_u32 s36, s64, s24
    s_addc_u32 s37, s65, 0
    s_add_u32 s8, s66, s20
    s_addc_u32 s9, s67, 0
    buffer_load_dwordx4 v8, s[36:39], 0 offen offset:0 nt lds
    buffer_load_dwordx4 v9, s[36:39], 0 offen offset:1024 nt lds
    buffer_load_dwordx4 v10, s[36:39], 0 offen offset:2048 nt lds
    buffer_load_dwordx4 v11, s[36:39], 0 offen offset:3072 nt lds
    s_add_u32 m0, s26, 0
    s_mov_b32 s30, 0
    buffer_load_dwordx4 v8, s[8:11], s30 offen offset:0 nt lds
    buffer_load_dwordx4 v9, s[8:11], s30 offen offset:1024 nt lds
    buffer_load_dwordx4 v10, s[8:11], s30 offen offset:2048 nt lds
    buffer_load_dwordx4 v11, s[8:11], s30 offen offset:3072 nt lds
    s_waitcnt vmcnt(7)
    s_add_u32 s12, s68, s20
    s_addc_u32 s13, s69, 0
    v_lshrrev_b32 v4, 3, v2
    v_and_b32 v3, 7, v2
    v_and_b32 v5, 6, v4
    v_xor_b32 v3, v3, v5
    v_lshlrev_b32 v4, 8, v4
    v_lshl_add_u32 v12, v3, 4, v4
    s_lshl_b32 s23, s22, 7
    v_add_u32 v12, s23, v12
    v_add_u32 v13, 1024, v12
    s_lshl_b32 s27, s3, 11
    s_add_u32 s27, s27, 65536
    s_add_u32 m0, s27, 0
    s_mov_b32 s31, 0
    buffer_load_dwordx4 v12, s[12:15], s31 offen offset:0 nt lds
    s_waitcnt vmcnt(7)
    buffer_load_dwordx4 v13, s[12:15], s31 offen offset:1024 nt lds
    s_waitcnt vmcnt(7)
    s_add_u32 m0, s26, 16384
    s_mov_b32 s30, 16384
    buffer_load_dwordx4 v8, s[8:11], s30 offen offset:0 nt lds
    s_waitcnt vmcnt(7)
    s_barrier
    buffer_load_dwordx4 v9, s[8:11], s30 offen offset:1024 nt lds
    s_waitcnt vmcnt(7)
    buffer_load_dwordx4 v10, s[8:11], s30 offen offset:2048 nt lds
    s_waitcnt vmcnt(7)
    buffer_load_dwordx4 v11, s[8:11], s30 offen offset:3072 nt lds
    s_waitcnt vmcnt(7)
    s_add_u32 m0, s27, 8192
    s_mov_b32 s31, 16384
    buffer_load_dwordx4 v12, s[12:15], s31 offen offset:0 nt lds
    s_waitcnt vmcnt(7)
    s_barrier
    buffer_load_dwordx4 v13, s[12:15], s31 offen offset:1024 nt lds
    s_waitcnt vmcnt(7)
    s_add_u32 m0, s26, 32768
    s_mov_b32 s30, 32768
    buffer_load_dwordx4 v8, s[8:11], s30 offen offset:0 nt lds
    s_waitcnt vmcnt(7)
    buffer_load_dwordx4 v9, s[8:11], s30 offen offset:1024 nt lds
    s_waitcnt vmcnt(7)
    buffer_load_dwordx4 v10, s[8:11], s30 offen offset:2048 nt lds
    s_waitcnt vmcnt(7)
    buffer_load_dwordx4 v11, s[8:11], s30 offen offset:3072 nt lds
    s_waitcnt vmcnt(7)
    s_add_u32 m0, s27, 16384
    s_mov_b32 s31, 32768
    buffer_load_dwordx4 v12, s[12:15], s31 offen offset:0 nt lds
    s_waitcnt vmcnt(7)
    s_barrier
    buffer_load_dwordx4 v13, s[12:15], s31 offen offset:1024 nt lds
    s_waitcnt vmcnt(7)
    s_add_u32 m0, s26, 49152
    s_mov_b32 s30, 49152
    buffer_load_dwordx4 v8, s[8:11], s30 offen offset:0 nt lds
    s_waitcnt vmcnt(7)
    buffer_load_dwordx4 v9, s[8:11], s30 offen offset:1024 nt lds
    s_waitcnt vmcnt(7)
    buffer_load_dwordx4 v10, s[8:11], s30 offen offset:2048 nt lds
    s_waitcnt vmcnt(7)
    buffer_load_dwordx4 v11, s[8:11], s30 offen offset:3072 nt lds
    s_waitcnt vmcnt(7)
    s_add_u32 m0, s27, 24576
    s_mov_b32 s31, 49152
    buffer_load_dwordx4 v12, s[12:15], s31 offen offset:0 nt lds
    s_waitcnt vmcnt(7)
    s_barrier
    buffer_load_dwordx4 v13, s[12:15], s31 offen offset:1024 nt lds
    s_waitcnt vmcnt(7)
    s_add_u32 m0, s26, 0
    s_mov_b32 s30, 65536
    buffer_load_dwordx4 v8, s[8:11], s30 offen offset:0 nt lds
    s_waitcnt vmcnt(7)
    buffer_load_dwordx4 v9, s[8:11], s30 offen offset:1024 nt lds
    s_waitcnt vmcnt(7)
    buffer_load_dwordx4 v10, s[8:11], s30 offen offset:2048 nt lds
    s_waitcnt vmcnt(7)
    buffer_load_dwordx4 v11, s[8:11], s30 offen offset:3072 nt lds
    s_waitcnt vmcnt(7)
    s_add_u32 m0, s27, 32768
    s_mov_b32 s31, 65536
    buffer_load_dwordx4 v12, s[12:15], s31 offen offset:0 nt lds
    s_waitcnt vmcnt(7)
    s_barrier
    buffer_load_dwordx4 v13, s[12:15], s31 offen offset:1024 nt lds
    s_waitcnt vmcnt(7)
    s_add_u32 m0, s26, 16384
    s_mov_b32 s30, 81920
    buffer_load_dwordx4 v8, s[8:11], s30 offen offset:0 nt lds
    s_waitcnt vmcnt(7)
    buffer_load_dwordx4 v9, s[8:11], s30 offen offset:1024 nt lds
    s_waitcnt vmcnt(7)
    buffer_load_dwordx4 v10, s[8:11], s30 offen offset:2048 nt lds
    s_waitcnt vmcnt(7)
    buffer_load_dwordx4 v11, s[8:11], s30 offen offset:3072 nt lds
    s_waitcnt vmcnt(7)
    s_add_u32 m0, s27, 40960
    s_mov_b32 s31, 81920
    buffer_load_dwordx4 v12, s[12:15], s31 offen offset:0 nt lds
    s_waitcnt vmcnt(7)
    s_barrier
    buffer_load_dwordx4 v13, s[12:15], s31 offen offset:1024 nt lds
    s_add_u32 m0, s26, 32768
    s_mov_b32 s30, 98304
    buffer_load_dwordx4 v8, s[8:11], s30 offen offset:0 nt lds
    buffer_load_dwordx4 v9, s[8:11], s30 offen offset:1024 nt lds
    s_waitcnt vmcnt(9)
    buffer_load_dwordx4 v10, s[8:11], s30 offen offset:2048 nt lds
    s_waitcnt vmcnt(9)
    buffer_load_dwordx4 v11, s[8:11], s30 offen offset:3072 nt lds
    s_waitcnt vmcnt(9)
    s_add_u32 m0, s27, 49152
    s_mov_b32 s31, 98304
    buffer_load_dwordx4 v12, s[12:15], s31 offen offset:0 nt lds
    s_waitcnt vmcnt(9)
    buffer_load_dwordx4 v13, s[12:15], s31 offen offset:1024 nt lds
    s_waitcnt vmcnt(9)
    s_add_u32 m0, s26, 49152
    s_mov_b32 s30, 114688
    buffer_load_dwordx4 v8, s[8:11], s30 offen offset:0 nt lds
    s_waitcnt vmcnt(9)
    s_barrier
    buffer_load_dwordx4 v9, s[8:11], s30 offen offset:1024 nt lds
    s_waitcnt vmcnt(9)
    buffer_load_dwordx4 v10, s[8:11], s30 offen offset:2048 nt lds
    s_waitcnt vmcnt(9)
    buffer_load_dwordx4 v11, s[8:11], s30 offen offset:3072 nt lds
    s_waitcnt vmcnt(9)
    s_add_u32 m0, s27, 57344
    s_mov_b32 s31, 114688
    buffer_load_dwordx4 v12, s[12:15], s31 offen offset:0 nt lds
    s_waitcnt vmcnt(9)
    buffer_load_dwordx4 v13, s[12:15], s31 offen offset:1024 nt lds
    s_waitcnt vmcnt(9)
    s_add_u32 m0, s26, 0
    s_mov_b32 s30, 131072
    buffer_load_dwordx4 v8, s[8:11], s30 offen offset:0 nt lds
    s_waitcnt vmcnt(9)
    s_barrier
    buffer_load_dwordx4 v9, s[8:11], s30 offen offset:1024 nt lds
    s_waitcnt vmcnt(9)
    buffer_load_dwordx4 v10, s[8:11], s30 offen offset:2048 nt lds
    s_waitcnt vmcnt(9)
    buffer_load_dwordx4 v11, s[8:11], s30 offen offset:3072 nt lds
    s_waitcnt vmcnt(9)
    s_add_u32 m0, s27, 0
    s_mov_b32 s31, 131072
    buffer_load_dwordx4 v12, s[12:15], s31 offen offset:0 nt lds
    s_waitcnt vmcnt(9)
    buffer_load_dwordx4 v13, s[12:15], s31 offen offset:1024 nt lds
    s_waitcnt vmcnt(9)
    s_add_u32 m0, s26, 16384
    s_mov_b32 s30, 147456
    buffer_load_dwordx4 v8, s[8:11], s30 offen offset:0 nt lds
    s_waitcnt vmcnt(9)
    s_barrier
    buffer_load_dwordx4 v9, s[8:11], s30 offen offset:1024 nt lds
    s_waitcnt vmcnt(9)
    buffer_load_dwordx4 v10, s[8:11], s30 offen offset:2048 nt lds
    s_waitcnt vmcnt(9)
    buffer_load_dwordx4 v11, s[8:11], s30 offen offset:3072 nt lds
    s_waitcnt vmcnt(9)
    s_add_u32 m0, s27, 8192
    s_mov_b32 s31, 147456
    buffer_load_dwordx4 v12, s[12:15], s31 offen offset:0 nt lds
    s_waitcnt vmcnt(9)
    buffer_load_dwordx4 v13, s[12:15], s31 offen offset:1024 nt lds
    s_waitcnt vmcnt(9)
    s_add_u32 m0, s26, 32768
    s_mov_b32 s30, 163840
    buffer_load_dwordx4 v8, s[8:11], s30 offen offset:0 nt lds
    s_waitcnt vmcnt(9)
    s_barrier
    buffer_load_dwordx4 v9, s[8:11], s30 offen offset:1024 nt lds
    s_waitcnt vmcnt(9)
    buffer_load_dwordx4 v10, s[8:11], s30 offen offset:2048 nt lds
    s_waitcnt vmcnt(9)
    buffer_load_dwordx4 v11, s[8:11], s30 offen offset:3072 nt lds
    s_waitcnt vmcnt(9)
    s_add_u32 m0, s27, 16384
    s_mov_b32 s31, 163840
    buffer_load_dwordx4 v12, s[12:15], s31 offen offset:0 nt lds
    s_waitcnt vmcnt(9)
    buffer_load_dwordx4 v13, s[12:15], s31 offen offset:1024 nt lds
    s_waitcnt vmcnt(9)
    s_add_u32 m0, s26, 49152
    s_mov_b32 s30, 180224
    buffer_load_dwordx4 v8, s[8:11], s30 offen offset:0 nt lds
    s_waitcnt vmcnt(9)
    s_barrier
    buffer_load_dwordx4 v9, s[8:11], s30 offen offset:1024 nt lds
    s_waitcnt vmcnt(9)
    buffer_load_dwordx4 v10, s[8:11], s30 offen offset:2048 nt lds
    s_waitcnt vmcnt(9)
    buffer_load_dwordx4 v11, s[8:11], s30 offen offset:3072 nt lds
    s_waitcnt vmcnt(9)
    s_add_u32 m0, s27, 24576
    s_mov_b32 s31, 180224
    buffer_load_dwordx4 v12, s[12:15], s31 offen offset:0 nt lds
    s_waitcnt vmcnt(9)
    buffer_load_dwordx4 v13, s[12:15], s31 offen offset:1024 nt lds
    s_waitcnt vmcnt(9)
    s_add_u32 m0, s26, 0
    s_mov_b32 s30, 196608
    buffer_load_dwordx4 v8, s[8:11], s30 offen offset:0 nt lds
    s_waitcnt vmcnt(9)
    s_barrier
    buffer_load_dwordx4 v9, s[8:11], s30 offen offset:1024 nt lds
    s_waitcnt vmcnt(9)
    buffer_load_dwordx4 v10, s[8:11], s30 offen offset:2048 nt lds
    s_waitcnt vmcnt(9)
    buffer_load_dwordx4 v11, s[8:11], s30 offen offset:3072 nt lds
    s_waitcnt vmcnt(9)
    s_add_u32 m0, s27, 32768
    s_mov_b32 s31, 196608
    buffer_load_dwordx4 v12, s[12:15], s31 offen offset:0 nt lds
    s_waitcnt vmcnt(9)
    buffer_load_dwordx4 v13, s[12:15], s31 offen offset:1024 nt lds
    s_waitcnt vmcnt(9)
    s_add_u32 m0, s26, 16384
    s_mov_b32 s30, 212992
    buffer_load_dwordx4 v8, s[8:11], s30 offen offset:0 nt lds
    s_waitcnt vmcnt(9)
    s_barrier
    buffer_load_dwordx4 v9, s[8:11], s30 offen offset:1024 nt lds
    s_waitcnt vmcnt(9)
    buffer_load_dwordx4 v10, s[8:11], s30 offen offset:2048 nt lds
    s_waitcnt vmcnt(9)
    buffer_load_dwordx4 v11, s[8:11], s30 offen offset:3072 nt lds
    s_waitcnt vmcnt(9)
    s_add_u32 m0, s27, 40960
    s_mov_b32 s31, 212992
    buffer_load_dwordx4 v12, s[12:15], s31 offen offset:0 nt lds
    s_waitcnt vmcnt(9)
    buffer_load_dwordx4 v13, s[12:15], s31 offen offset:1024 nt lds
    s_waitcnt vmcnt(9)
    s_add_u32 m0, s26, 32768
    s_mov_b32 s30, 229376
    buffer_load_dwordx4 v8, s[8:11], s30 offen offset:0 nt lds
    s_waitcnt vmcnt(9)
    s_barrier
    buffer_load_dwordx4 v9, s[8:11], s30 offen offset:1024 nt lds
    s_waitcnt vmcnt(9)
    buffer_load_dwordx4 v10, s[8:11], s30 offen offset:2048 nt lds
    s_waitcnt vmcnt(9)
    buffer_load_dwordx4 v11, s[8:11], s30 offen offset:3072 nt lds
    s_waitcnt vmcnt(9)
    s_add_u32 m0, s27, 49152
    s_mov_b32 s31, 229376
    buffer_load_dwordx4 v12, s[12:15], s31 offen offset:0 nt lds
    s_waitcnt vmcnt(9)
    buffer_load_dwordx4 v13, s[12:15], s31 offen offset:1024 nt lds
    s_waitcnt vmcnt(9)
    s_add_u32 m0, s26, 49152
    s_mov_b32 s30, 245760
    buffer_load_dwordx4 v8, s[8:11], s30 offen offset:0 nt lds
    s_waitcnt vmcnt(9)
    s_barrier
    buffer_load_dwordx4 v9, s[8:11], s30 offen offset:1024 nt lds
    s_waitcnt vmcnt(9)
    buffer_load_dwordx4 v10, s[8:11], s30 offen offset:2048 nt lds
    s_waitcnt vmcnt(9)
    buffer_load_dwordx4 v11, s[8:11], s30 offen offset:3072 nt lds
    s_waitcnt vmcnt(9)
    s_add_u32 m0, s27, 57344
    s_mov_b32 s31, 245760
    buffer_load_dwordx4 v12, s[12:15], s31 offen offset:0 nt lds
    s_waitcnt vmcnt(9)
    buffer_load_dwordx4 v13, s[12:15], s31 offen offset:1024 nt lds
    s_waitcnt vmcnt(9)
    s_add_u32 m0, s26, 0
    s_mov_b32 s30, 262144
    buffer_load_dwordx4 v8, s[8:11], s30 offen offset:0 nt lds
    s_waitcnt vmcnt(9)
    s_barrier
    buffer_load_dwordx4 v9, s[8:11], s30 offen offset:1024 nt lds
    s_waitcnt vmcnt(9)
    buffer_load_dwordx4 v10, s[8:11], s30 offen offset:2048 nt lds
    s_waitcnt vmcnt(9)
    buffer_load_dwordx4 v11, s[8:11], s30 offen offset:3072 nt lds
    s_waitcnt vmcnt(9)
    s_add_u32 m0, s27, 0
    s_mov_b32 s31, 262144
    buffer_load_dwordx4 v12, s[12:15], s31 offen offset:0 nt lds
    s_waitcnt vmcnt(9)
    buffer_load_dwordx4 v13, s[12:15], s31 offen offset:1024 nt lds
    s_waitcnt vmcnt(9)
    s_add_u32 m0, s26, 16384
    s_mov_b32 s30, 278528
    buffer_load_dwordx4 v8, s[8:11], s30 offen offset:0 nt lds
    s_waitcnt vmcnt(9)
    s_barrier
    buffer_load_dwordx4 v9, s[8:11], s30 offen offset:1024 nt lds
    s_waitcnt vmcnt(9)
    buffer_load_dwordx4 v10, s[8:11], s30 offen offset:2048 nt lds
    s_waitcnt vmcnt(9)
    buffer_load_dwordx4 v11, s[8:11], s30 offen offset:3072 nt lds
    s_waitcnt vmcnt(9)
    s_add_u32 m0, s27, 8192
    s_mov_b32 s31, 278528
    buffer_load_dwordx4 v12, s[12:15], s31 offen offset:0 nt lds
    s_waitcnt vmcnt(9)
    buffer_load_dwordx4 v13, s[12:15], s31 offen offset:1024 nt lds
    s_waitcnt vmcnt(9)
    s_add_u32 m0, s26, 32768
    s_mov_b32 s30, 294912
    buffer_load_dwordx4 v8, s[8:11], s30 offen offset:0 nt lds
    s_waitcnt vmcnt(9)
    s_barrier
    buffer_load_dwordx4 v9, s[8:11], s30 offen offset:1024 nt lds
    s_waitcnt vmcnt(9)
    buffer_load_dwordx4 v10, s[8:11], s30 offen offset:2048 nt lds
    s_waitcnt vmcnt(9)
    buffer_load_dwordx4 v11, s[8:11], s30 offen offset:3072 nt lds
    s_waitcnt vmcnt(9)
    s_add_u32 m0, s27, 16384
    s_mov_b32 s31, 294912
    buffer_load_dwordx4 v12, s[12:15], s31 offen offset:0 nt lds
    s_waitcnt vmcnt(9)
    buffer_load_dwordx4 v13, s[12:15], s31 offen offset:1024 nt lds
    s_waitcnt vmcnt(9)
    s_add_u32 m0, s26, 49152
    s_mov_b32 s30, 311296
    buffer_load_dwordx4 v8, s[8:11], s30 offen offset:0 nt lds
    s_waitcnt vmcnt(9)
    s_barrier
    buffer_load_dwordx4 v9, s[8:11], s30 offen offset:1024 nt lds
    s_waitcnt vmcnt(9)
    buffer_load_dwordx4 v10, s[8:11], s30 offen offset:2048 nt lds
    s_waitcnt vmcnt(9)
    buffer_load_dwordx4 v11, s[8:11], s30 offen offset:3072 nt lds
    s_waitcnt vmcnt(9)
    s_add_u32 m0, s27, 24576
    s_mov_b32 s31, 311296
    buffer_load_dwordx4 v12, s[12:15], s31 offen offset:0 nt lds
    s_waitcnt vmcnt(9)
    buffer_load_dwordx4 v13, s[12:15], s31 offen offset:1024 nt lds
    s_waitcnt vmcnt(9)
    s_add_u32 m0, s26, 0
    s_mov_b32 s30, 327680
    buffer_load_dwordx4 v8, s[8:11], s30 offen offset:0 nt lds
    s_waitcnt vmcnt(9)
    s_barrier
    buffer_load_dwordx4 v9, s[8:11], s30 offen offset:1024 nt lds
    s_waitcnt vmcnt(9)
    buffer_load_dwordx4 v10, s[8:11], s30 offen offset:2048 nt lds
    s_waitcnt vmcnt(9)
    buffer_load_dwordx4 v11, s[8:11], s30 offen offset:3072 nt lds
    s_waitcnt vmcnt(9)
    s_add_u32 m0, s27, 32768
    s_mov_b32 s31, 327680
    buffer_load_dwordx4 v12, s[12:15], s31 offen offset:0 nt lds
    s_waitcnt vmcnt(9)
    buffer_load_dwordx4 v13, s[12:15], s31 offen offset:1024 nt lds
    s_waitcnt vmcnt(9)
    s_add_u32 m0, s26, 16384
    s_mov_b32 s30, 344064
    buffer_load_dwordx4 v8, s[8:11], s30 offen offset:0 nt lds
    s_waitcnt vmcnt(9)
    s_barrier
    buffer_load_dwordx4 v9, s[8:11], s30 offen offset:1024 nt lds
    s_waitcnt vmcnt(9)
    buffer_load_dwordx4 v10, s[8:11], s30 offen offset:2048 nt lds
    s_waitcnt vmcnt(9)
    buffer_load_dwordx4 v11, s[8:11], s30 offen offset:3072 nt lds
    s_waitcnt vmcnt(9)
    s_add_u32 m0, s27, 40960
    s_mov_b32 s31, 344064
    buffer_load_dwordx4 v12, s[12:15], s31 offen offset:0 nt lds
    s_waitcnt vmcnt(9)
    buffer_load_dwordx4 v13, s[12:15], s31 offen offset:1024 nt lds
    s_waitcnt vmcnt(9)
    s_add_u32 m0, s26, 32768
    s_mov_b32 s30, 360448
    buffer_load_dwordx4 v8, s[8:11], s30 offen offset:0 nt lds
    s_waitcnt vmcnt(9)
    s_barrier
    buffer_load_dwordx4 v9, s[8:11], s30 offen offset:1024 nt lds
    s_waitcnt vmcnt(9)
    buffer_load_dwordx4 v10, s[8:11], s30 offen offset:2048 nt lds
    s_waitcnt vmcnt(9)
    buffer_load_dwordx4 v11, s[8:11], s30 offen offset:3072 nt lds
    s_waitcnt vmcnt(9)
    s_add_u32 m0, s27, 49152
    s_mov_b32 s31, 360448
    buffer_load_dwordx4 v12, s[12:15], s31 offen offset:0 nt lds
    s_waitcnt vmcnt(9)
    buffer_load_dwordx4 v13, s[12:15], s31 offen offset:1024 nt lds
    s_waitcnt vmcnt(9)
    s_add_u32 m0, s26, 49152
    s_mov_b32 s30, 376832
    buffer_load_dwordx4 v8, s[8:11], s30 offen offset:0 nt lds
    s_waitcnt vmcnt(9)
    s_barrier
    buffer_load_dwordx4 v9, s[8:11], s30 offen offset:1024 nt lds
    s_waitcnt vmcnt(9)
    buffer_load_dwordx4 v10, s[8:11], s30 offen offset:2048 nt lds
    s_waitcnt vmcnt(9)
    buffer_load_dwordx4 v11, s[8:11], s30 offen offset:3072 nt lds
    s_waitcnt vmcnt(9)
    s_add_u32 m0, s27, 57344
    s_mov_b32 s31, 376832
    buffer_load_dwordx4 v12, s[12:15], s31 offen offset:0 nt lds
    s_waitcnt vmcnt(9)
    s_add_u32 m0, s26, 0
    s_mov_b32 s30, 393216
    buffer_load_dwordx4 v8, s[8:11], s30 offen offset:0 nt lds
    s_waitcnt vmcnt(9)
    buffer_load_dwordx4 v9, s[8:11], s30 offen offset:1024 nt lds
    s_waitcnt vmcnt(9)
    s_barrier
    buffer_load_dwordx4 v10, s[8:11], s30 offen offset:2048 nt lds
    s_add_u32 m0, s27, 57344
    s_mov_b32 s31, 376832
    buffer_load_dwordx4 v13, s[12:15], s31 offen offset:1024 nt lds
    s_add_u32 m0, s26, 0
    s_mov_b32 s30, 393216
    buffer_load_dwordx4 v11, s[8:11], s30 offen offset:3072 nt lds
    s_waitcnt vmcnt(11)
    s_add_u32 m0, s26, 16384
    s_mov_b32 s30, 409600
    buffer_load_dwordx4 v8, s[8:11], s30 offen offset:0 nt lds
    s_waitcnt vmcnt(11)
    buffer_load_dwordx4 v9, s[8:11], s30 offen offset:1024 nt lds
    s_waitcnt vmcnt(11)
    buffer_load_dwordx4 v10, s[8:11], s30 offen offset:2048 nt lds
    s_waitcnt vmcnt(11)
    buffer_load_dwordx4 v11, s[8:11], s30 offen offset:3072 nt lds
    s_waitcnt vmcnt(11)
    s_add_u32 m0, s27, 0
    s_mov_b32 s31, 393216
    buffer_load_dwordx4 v12, s[12:15], s31 offen offset:0 nt lds
    s_waitcnt vmcnt(11)
    s_barrier
    s_add_u32 m0, s26, 32768
    s_mov_b32 s30, 425984
    buffer_load_dwordx4 v8, s[8:11], s30 offen offset:0 nt lds
    s_waitcnt vmcnt(11)
    buffer_load_dwordx4 v9, s[8:11], s30 offen offset:1024 nt lds
    s_waitcnt vmcnt(11)
    buffer_load_dwordx4 v10, s[8:11], s30 offen offset:2048 nt lds
    s_waitcnt vmcnt(11)
    s_add_u32 m0, s27, 0
    s_mov_b32 s31, 393216
    buffer_load_dwordx4 v13, s[12:15], s31 offen offset:1024 nt lds
    s_waitcnt vmcnt(11)
    s_add_u32 m0, s26, 32768
    s_mov_b32 s30, 425984
    buffer_load_dwordx4 v11, s[8:11], s30 offen offset:3072 nt lds
    s_waitcnt vmcnt(10)
    s_barrier
    s_add_u32 m0, s26, 49152
    s_mov_b32 s30, 442368
    buffer_load_dwordx4 v8, s[8:11], s30 offen offset:0 nt lds
    buffer_load_dwordx4 v9, s[8:11], s30 offen offset:1024 nt lds
    s_waitcnt vmcnt(11)
    buffer_load_dwordx4 v10, s[8:11], s30 offen offset:2048 nt lds
    s_waitcnt vmcnt(11)
    buffer_load_dwordx4 v11, s[8:11], s30 offen offset:3072 nt lds
    s_waitcnt vmcnt(11)
    s_add_u32 m0, s27, 8192
    s_mov_b32 s31, 409600
    buffer_load_dwordx4 v12, s[12:15], s31 offen offset:0 nt lds
    s_waitcnt vmcnt(11)
    s_barrier
    s_add_u32 m0, s26, 0
    s_mov_b32 s30, 458752
    buffer_load_dwordx4 v8, s[8:11], s30 offen offset:0 nt lds
    s_waitcnt vmcnt(11)
    buffer_load_dwordx4 v9, s[8:11], s30 offen offset:1024 nt lds
    s_waitcnt vmcnt(11)
    buffer_load_dwordx4 v10, s[8:11], s30 offen offset:2048 nt lds
    s_waitcnt vmcnt(11)
    s_add_u32 m0, s27, 8192
    s_mov_b32 s31, 409600
    buffer_load_dwordx4 v13, s[12:15], s31 offen offset:1024 nt lds
    s_waitcnt vmcnt(11)
    s_add_u32 m0, s26, 0
    s_mov_b32 s30, 458752
    buffer_load_dwordx4 v11, s[8:11], s30 offen offset:3072 nt lds
    s_waitcnt vmcnt(10)
    s_barrier
    s_add_u32 m0, s26, 16384
    s_mov_b32 s30, 475136
    buffer_load_dwordx4 v8, s[8:11], s30 offen offset:0 nt lds
    buffer_load_dwordx4 v9, s[8:11], s30 offen offset:1024 nt lds
    s_waitcnt vmcnt(11)
    buffer_load_dwordx4 v10, s[8:11], s30 offen offset:2048 nt lds
    s_waitcnt vmcnt(11)
    buffer_load_dwordx4 v11, s[8:11], s30 offen offset:3072 nt lds
    s_waitcnt vmcnt(11)
    s_add_u32 m0, s27, 16384
    s_mov_b32 s31, 425984
    buffer_load_dwordx4 v12, s[12:15], s31 offen offset:0 nt lds
    s_waitcnt vmcnt(11)
    s_barrier
    buffer_load_dwordx4 v13, s[12:15], s31 offen offset:1024 nt lds
    s_waitcnt vmcnt(11)
    s_add_u32 m0, s26, 32768
    s_mov_b32 s30, 491520
    buffer_load_dwordx4 v8, s[8:11], s30 offen offset:0 nt lds
    s_waitcnt vmcnt(11)
    buffer_load_dwordx4 v9, s[8:11], s30 offen offset:1024 nt lds
    s_waitcnt vmcnt(11)
    buffer_load_dwordx4 v10, s[8:11], s30 offen offset:2048 nt lds
    s_waitcnt vmcnt(11)
    buffer_load_dwordx4 v11, s[8:11], s30 offen offset:3072 nt lds
    s_waitcnt vmcnt(11)
    s_add_u32 m0, s27, 24576
    s_mov_b32 s31, 442368
    buffer_load_dwordx4 v12, s[12:15], s31 offen offset:0 nt lds
    s_waitcnt vmcnt(11)
    s_barrier
    buffer_load_dwordx4 v13, s[12:15], s31 offen offset:1024 nt lds
    s_waitcnt vmcnt(11)
    s_add_u32 m0, s26, 49152
    s_mov_b32 s30, 507904
    buffer_load_dwordx4 v8, s[8:11], s30 offen offset:0 nt lds
    s_waitcnt vmcnt(11)
    buffer_load_dwordx4 v9, s[8:11], s30 offen offset:1024 nt lds
    s_waitcnt vmcnt(11)
    buffer_load_dwordx4 v10, s[8:11], s30 offen offset:2048 nt lds
    s_waitcnt vmcnt(11)
    s_barrier
    buffer_load_dwordx4 v11, s[8:11], s30 offen offset:3072 nt lds
    s_waitcnt vmcnt(7)
    s_add_u32 m0, s27, 32768
    s_mov_b32 s31, 458752
    buffer_load_dwordx4 v12, s[12:15], s31 offen offset:0 nt lds
    s_waitcnt vmcnt(7)
    s_barrier
    buffer_load_dwordx4 v13, s[12:15], s31 offen offset:1024 nt lds
    s_waitcnt vmcnt(7)
    s_add_u32 m0, s27, 40960
    s_mov_b32 s31, 475136
    buffer_load_dwordx4 v12, s[12:15], s31 offen offset:0 nt lds
    s_waitcnt vmcnt(7)
    buffer_load_dwordx4 v13, s[12:15], s31 offen offset:1024 nt lds
    s_waitcnt vmcnt(7)
    s_add_u32 m0, s27, 49152
    s_mov_b32 s31, 491520
    buffer_load_dwordx4 v12, s[12:15], s31 offen offset:0 nt lds
    s_waitcnt vmcnt(7)
    buffer_load_dwordx4 v13, s[12:15], s31 offen offset:1024 nt lds
    s_waitcnt vmcnt(7)
    s_add_u32 m0, s27, 57344
    s_mov_b32 s31, 507904
    buffer_load_dwordx4 v12, s[12:15], s31 offen offset:0 nt lds
    s_waitcnt vmcnt(7)
    s_barrier
    buffer_load_dwordx4 v13, s[12:15], s31 offen offset:1024 nt lds
    s_waitcnt vmcnt(4)
    s_barrier
    s_waitcnt vmcnt(0)
    s_barrier
    s_endpgm
L_compute:
    s_sub_u32 s3, s3, 4
    s_and_b32 s23, s3, 1
    s_lshr_b32 s24, s3, 1
    s_lshl_b32 s20, s21, 14
    s_lshl_b32 s25, s23, 13
    s_add_u32 s20, s20, s25
    s_lshl_b32 s26, s22, 7
    s_add_u32 s20, s20, s26
    s_lshl_b32 s26, s24, 6
    s_add_u32 s20, s20, s26
    v_lshlrev_b32 v5, 8, v3
    s_add_u32 s25, s25, 131072
    v_add_u32 v7, s25, v5
    v_xor_b32 v1, 0, v6
    v_lshl_add_u32 v204, v1, 4, v7
    v_xor_b32 v1, 4, v6
    v_lshl_add_u32 v205, v1, 4, v7
    v_xor_b32 v1, 8, v6
    v_lshl_add_u32 v206, v1, 4, v7
    v_xor_b32 v1, 12, v6
    v_lshl_add_u32 v207, v1, 4, v7
    s_lshl_b32 s26, s24, 13
    s_sub_u32 s27, s26, s25
    v_and_b32 v1, 1, v4
    v_lshl_add_u32 v6, v1, 5, v5
    v_lshrrev_b32 v1, 1, v4
    v_lshl_add_u32 v6, v1, 4, v6
    v_lshrrev_b32 v1, 2, v3
    v_lshl_add_u32 v5, v4, 2, v1
    v_bfe_u32 v7, v5, 1, 2
    v_lshlrev_b32 v5, 7, v5
    v_and_b32 v1, 3, v3
    v_lshl_add_u32 v5, v1, 3, v5
    s_lshl_b32 s25, s24, 12
    s_add_u32 s25, s25, 65536
    v_add_u32 v5, s25, v5
    s_lshl_b32 s26, s24, 1
    v_xor_b32 v7, s26, v7
    v_xor_b32 v1, 0, v7
    v_lshl_add_u32 v208, v1, 5, v5
    v_xor_b32 v1, 1, v7
    v_lshl_add_u32 v209, v1, 5, v5
    v_xor_b32 v1, 2, v7
    v_lshl_add_u32 v210, v1, 5, v5
    v_xor_b32 v1, 3, v7
    v_lshl_add_u32 v211, v1, 5, v5
    s_lshl_b32 s25, s3, 12
    s_add_u32 s25, s25, 131072
    v_lshl_add_u32 v218, v2, 4, s25
    v_xor_b32 v219, 8192, v218
    v_subrev_u32 v1, 131072, v218
    v_xor_b32 v7, 8192, v1
    s_mov_b32 s34, 0x3e0293ee
    s_mov_b32 s35, s34
    s_mov_b32 s33, 0x41000000
    s_movk_i32 s28, 4096
    v_mov_b32 v152, 0
    v_mov_b32 v153, 0
    v_mov_b32 v154, 0
    v_mov_b32 v155, 0
    v_mov_b32 v156, 0
    v_mov_b32 v157, 0
    v_mov_b32 v158, 0
    v_mov_b32 v159, 0
    v_mov_b32 v160, 0
    v_mov_b32 v161, 0
    v_mov_b32 v162, 0
    v_mov_b32 v163, 0
    v_mov_b32 v164, 0
    v_mov_b32 v165, 0
    v_mov_b32 v166, 0
    v_mov_b32 v167, 0
    v_mov_b32 v168, 0
    v_mov_b32 v169, 0
    v_mov_b32 v170, 0
    v_mov_b32 v171, 0
    v_mov_b32 v172, 0
    v_mov_b32 v173, 0
    v_mov_b32 v174, 0
    v_mov_b32 v175, 0
    v_mov_b32 v176, 0
    v_mov_b32 v177, 0
    v_mov_b32 v178, 0
    v_mov_b32 v179, 0
    v_mov_b32 v180, 0
    v_mov_b32 v181, 0
    v_mov_b32 v182, 0
    v_mov_b32 v183, 0
    v_mov_b32 v184, 0
    v_mov_b32 v185, 0
    v_mov_b32 v186, 0
    v_mov_b32 v187, 0
    v_mov_b32 v188, 0
    v_mov_b32 v189, 0
    v_mov_b32 v190, 0
    v_mov_b32 v191, 0
    v_mov_b32 v200, 0x3f803f80
    v_mov_b32 v201, 0x3f803f80
    v_mov_b32 v202, 0x3f803f80
    v_mov_b32 v203, 0x3f803f80
    s_mov_b32 s32, 0
    s_waitcnt lgkmcnt(0)
    s_add_u32 s12, s70, s20
    s_addc_u32 s13, s71, 0
    s_mov_b32 s14, 8000
    s_mov_b32 s15, 0x20000
    s_barrier
    ds_read_b128 v[8:11], v204 offset:0
    ds_read_b128 v[12:15], v205 offset:0
    ds_read_b128 v[16:19], v206 offset:0
    ds_read_b128 v[20:23], v207 offset:0
    ds_read_b128 v[24:27], v204 offset:4096
    ds_read_b128 v[28:31], v205 offset:4096
    ds_read_b128 v[32:35], v206 offset:4096
    ds_read_b128 v[36:39], v207 offset:4096
    v_add_u32 v204, s27, v204
    v_add_u32 v205, s27, v205
    v_add_u32 v206, s27, v206
    v_add_u32 v207, s27, v207
    s_waitcnt lgkmcnt(7)
    v_lshlrev_b32 v104, 16, v8
    v_and_b32 v105, 0xffff0000, v8
    v_pk_mul_f32 v[104:105], v[104:105], s[34:35]
    v_cvt_pk_bf16_f32 v8, v104, v105
    v_lshlrev_b32 v106, 16, v9
    v_and_b32 v107, 0xffff0000, v9
    v_pk_mul_f32 v[106:107], v[106:107], s[34:35]
    v_cvt_pk_bf16_f32 v9, v106, v107
    v_lshlrev_b32 v108, 16, v10
    v_and_b32 v109, 0xffff0000, v10
    v_pk_mul_f32 v[108:109], v[108:109], s[34:35]
    v_cvt_pk_bf16_f32 v10, v108, v109
    v_lshlrev_b32 v110, 16, v11
    v_and_b32 v111, 0xffff0000, v11
    v_pk_mul_f32 v[110:111], v[110:111], s[34:35]
    v_cvt_pk_bf16_f32 v11, v110, v111
    s_waitcnt lgkmcnt(6)
    v_lshlrev_b32 v104, 16, v12
    v_and_b32 v105, 0xffff0000, v12
    v_pk_mul_f32 v[104:105], v[104:105], s[34:35]
    v_cvt_pk_bf16_f32 v12, v104, v105
    v_lshlrev_b32 v106, 16, v13
    v_and_b32 v107, 0xffff0000, v13
    v_pk_mul_f32 v[106:107], v[106:107], s[34:35]
    v_cvt_pk_bf16_f32 v13, v106, v107
    v_lshlrev_b32 v108, 16, v14
    v_and_b32 v109, 0xffff0000, v14
    v_pk_mul_f32 v[108:109], v[108:109], s[34:35]
    v_cvt_pk_bf16_f32 v14, v108, v109
    v_lshlrev_b32 v110, 16, v15
    v_and_b32 v111, 0xffff0000, v15
    v_pk_mul_f32 v[110:111], v[110:111], s[34:35]
    v_cvt_pk_bf16_f32 v15, v110, v111
    s_waitcnt lgkmcnt(5)
    v_lshlrev_b32 v104, 16, v16
    v_and_b32 v105, 0xffff0000, v16
    v_pk_mul_f32 v[104:105], v[104:105], s[34:35]
    v_cvt_pk_bf16_f32 v16, v104, v105
    v_lshlrev_b32 v106, 16, v17
    v_and_b32 v107, 0xffff0000, v17
    v_pk_mul_f32 v[106:107], v[106:107], s[34:35]
    v_cvt_pk_bf16_f32 v17, v106, v107
    v_lshlrev_b32 v108, 16, v18
    v_and_b32 v109, 0xffff0000, v18
    v_pk_mul_f32 v[108:109], v[108:109], s[34:35]
    v_cvt_pk_bf16_f32 v18, v108, v109
    v_lshlrev_b32 v110, 16, v19
    v_and_b32 v111, 0xffff0000, v19
    v_pk_mul_f32 v[110:111], v[110:111], s[34:35]
    v_cvt_pk_bf16_f32 v19, v110, v111
    s_waitcnt lgkmcnt(4)
    v_lshlrev_b32 v104, 16, v20
    v_and_b32 v105, 0xffff0000, v20
    v_pk_mul_f32 v[104:105], v[104:105], s[34:35]
    v_cvt_pk_bf16_f32 v20, v104, v105
    v_lshlrev_b32 v106, 16, v21
    v_and_b32 v107, 0xffff0000, v21
    v_pk_mul_f32 v[106:107], v[106:107], s[34:35]
    v_cvt_pk_bf16_f32 v21, v106, v107
    v_lshlrev_b32 v108, 16, v22
    v_and_b32 v109, 0xffff0000, v22
    v_pk_mul_f32 v[108:109], v[108:109], s[34:35]
    v_cvt_pk_bf16_f32 v22, v108, v109
    v_lshlrev_b32 v110, 16, v23
    v_and_b32 v111, 0xffff0000, v23
    v_pk_mul_f32 v[110:111], v[110:111], s[34:35]
    v_cvt_pk_bf16_f32 v23, v110, v111
    s_waitcnt lgkmcnt(0)
    s_barrier
    ds_read_b128 v[40:43], v204 offset:0
    ds_read_b128 v[56:59], v204 offset:4096
    ds_read_b128 v[44:47], v205 offset:0
    ds_read_b128 v[60:63], v205 offset:4096
    ds_read_b128 v[48:51], v206 offset:0
    ds_read_b128 v[64:67], v206 offset:4096
    ds_read_b128 v[52:55], v207 offset:0
    ds_read_b128 v[68:71], v207 offset:4096
    v_lshlrev_b32 v104, 16, v24
    v_and_b32 v105, 0xffff0000, v24
    v_pk_mul_f32 v[104:105], v[104:105], s[34:35]
    v_cvt_pk_bf16_f32 v24, v104, v105
    v_lshlrev_b32 v106, 16, v25
    v_and_b32 v107, 0xffff0000, v25
    v_pk_mul_f32 v[106:107], v[106:107], s[34:35]
    v_cvt_pk_bf16_f32 v25, v106, v107
    v_lshlrev_b32 v108, 16, v26
    v_and_b32 v109, 0xffff0000, v26
    v_pk_mul_f32 v[108:109], v[108:109], s[34:35]
    v_cvt_pk_bf16_f32 v26, v108, v109
    v_lshlrev_b32 v110, 16, v27
    v_and_b32 v111, 0xffff0000, v27
    v_pk_mul_f32 v[110:111], v[110:111], s[34:35]
    v_cvt_pk_bf16_f32 v27, v110, v111
    s_waitcnt lgkmcnt(0)
    v_lshlrev_b32 v104, 16, v28
    v_and_b32 v105, 0xffff0000, v28
    v_pk_mul_f32 v[104:105], v[104:105], s[34:35]
    v_cvt_pk_bf16_f32 v28, v104, v105
    v_mfma_f32_16x16x32_bf16 v[88:91], v[40:43], v[8:11], 0
    v_lshlrev_b32 v106, 16, v29
    v_and_b32 v107, 0xffff0000, v29
    v_pk_mul_f32 v[106:107], v[106:107], s[34:35]
    v_cvt_pk_bf16_f32 v29, v106, v107
    v_mfma_f32_16x16x32_bf16 v[92:95], v[56:59], v[8:11], 0
    v_lshlrev_b32 v108, 16, v30
    v_and_b32 v109, 0xffff0000, v30
    v_pk_mul_f32 v[108:109], v[108:109], s[34:35]
    v_cvt_pk_bf16_f32 v30, v108, v109
    v_mfma_f32_16x16x32_bf16 v[88:91], v[44:47], v[12:15], v[88:91]
    v_lshlrev_b32 v110, 16, v31
    v_and_b32 v111, 0xffff0000, v31
    v_pk_mul_f32 v[110:111], v[110:111], s[34:35]
    v_cvt_pk_bf16_f32 v31, v110, v111
    v_mfma_f32_16x16x32_bf16 v[92:95], v[60:63], v[12:15], v[92:95]
    v_lshlrev_b32 v104, 16, v32
    v_and_b32 v105, 0xffff0000, v32
    v_pk_mul_f32 v[104:105], v[104:105], s[34:35]
    v_cvt_pk_bf16_f32 v32, v104, v105
    v_mfma_f32_16x16x32_bf16 v[88:91], v[48:51], v[16:19], v[88:91]
    v_lshlrev_b32 v106, 16, v33
    v_and_b32 v107, 0xffff0000, v33
    v_pk_mul_f32 v[106:107], v[106:107], s[34:35]
    v_cvt_pk_bf16_f32 v33, v106, v107
    v_mfma_f32_16x16x32_bf16 v[92:95], v[64:67], v[16:19], v[92:95]
    v_lshlrev_b32 v108, 16, v34
    v_and_b32 v109, 0xffff0000, v34
    v_pk_mul_f32 v[108:109], v[108:109], s[34:35]
    v_cvt_pk_bf16_f32 v34, v108, v109
    v_mfma_f32_16x16x32_bf16 v[88:91], v[52:55], v[20:23], v[88:91]
    v_lshlrev_b32 v110, 16, v35
    v_and_b32 v111, 0xffff0000, v35
    v_pk_mul_f32 v[110:111], v[110:111], s[34:35]
    v_cvt_pk_bf16_f32 v35, v110, v111
    v_mfma_f32_16x16x32_bf16 v[92:95], v[68:71], v[20:23], v[92:95]
    v_lshlrev_b32 v104, 16, v36
    v_and_b32 v105, 0xffff0000, v36
    v_pk_mul_f32 v[104:105], v[104:105], s[34:35]
    v_cvt_pk_bf16_f32 v36, v104, v105
    v_lshlrev_b32 v106, 16, v37
    v_and_b32 v107, 0xffff0000, v37
    v_pk_mul_f32 v[106:107], v[106:107], s[34:35]
    v_cvt_pk_bf16_f32 v37, v106, v107
    v_lshlrev_b32 v108, 16, v38
    v_and_b32 v109, 0xffff0000, v38
    v_pk_mul_f32 v[108:109], v[108:109], s[34:35]
    v_cvt_pk_bf16_f32 v38, v108, v109
    v_lshlrev_b32 v110, 16, v39
    v_and_b32 v111, 0xffff0000, v39
    v_pk_mul_f32 v[110:111], v[110:111], s[34:35]
    v_cvt_pk_bf16_f32 v39, v110, v111
    s_nop 1
    v_mfma_f32_16x16x32_bf16 v[96:99], v[40:43], v[24:27], 0
    v_mfma_f32_16x16x32_bf16 v[100:103], v[56:59], v[24:27], 0
    v_mfma_f32_16x16x32_bf16 v[96:99], v[44:47], v[28:31], v[96:99]
    v_mfma_f32_16x16x32_bf16 v[100:103], v[60:63], v[28:31], v[100:103]
    v_mfma_f32_16x16x32_bf16 v[96:99], v[48:51], v[32:35], v[96:99]
    v_mfma_f32_16x16x32_bf16 v[100:103], v[64:67], v[32:35], v[100:103]
    v_mfma_f32_16x16x32_bf16 v[96:99], v[52:55], v[36:39], v[96:99]
    v_mfma_f32_16x16x32_bf16 v[100:103], v[68:71], v[36:39], v[100:103]
    s_waitcnt lgkmcnt(0)
    s_barrier
    ds_read_b128 v[40:43], v204 offset:16384
    ds_read_b128 v[56:59], v204 offset:20480
    ds_read_b128 v[44:47], v205 offset:16384
    ds_read_b128 v[60:63], v205 offset:20480
    ds_read_b128 v[48:51], v206 offset:16384
    ds_read_b128 v[64:67], v206 offset:20480
    ds_read_b128 v[52:55], v207 offset:16384
    ds_read_b128 v[68:71], v207 offset:20480
    v_max3_f32 v212, v88, v89, v90
    v_max3_f32 v213, v96, v97, v98
    v_max3_f32 v212, v212, v91, v92
    v_max3_f32 v213, v213, v99, v100
    v_max3_f32 v212, v212, v93, v94
    v_max3_f32 v213, v213, v101, v102
    v_max_f32 v212, v212, v95
    v_max_f32 v213, v213, v103
    v_mov_b32 v214, v212
    v_mov_b32 v215, v213
    s_nop 1
    v_permlane32_swap_b32 v212, v214
    v_permlane32_swap_b32 v213, v215
    v_max_f32 v212, v212, v214
    v_max_f32 v213, v213, v215
    v_mov_b32 v214, v212
    v_mov_b32 v215, v213
    s_nop 1
    v_permlane16_swap_b32 v212, v214
    v_permlane16_swap_b32 v213, v215
    v_max_f32 v212, v212, v214
    v_max_f32 v213, v213, v215
    v_ceil_f32 v212, v212
    v_sub_f32 v192, 0, v212
    v_sub_f32 v193, 0, v212
    v_sub_f32 v194, 0, v212
    v_sub_f32 v195, 0, v212
    v_ceil_f32 v213, v213
    v_sub_f32 v196, 0, v213
    v_sub_f32 v197, 0, v213
    v_sub_f32 v198, 0, v213
    v_sub_f32 v199, 0, v213
    s_nop 0
    v_sub_f32 v88, v88, v212
    v_sub_f32 v89, v89, v212
    v_sub_f32 v90, v90, v212
    v_sub_f32 v91, v91, v212
    s_waitcnt lgkmcnt(7)
    v_mfma_f32_16x16x32_bf16 v[104:107], v[40:43], v[8:11], v[192:195]
    v_sub_f32 v92, v92, v212
    v_sub_f32 v93, v93, v212
    v_sub_f32 v94, v94, v212
    v_mfma_f32_16x16x32_bf16 v[112:115], v[40:43], v[24:27], v[196:199]
    v_sub_f32 v95, v95, v212
    v_sub_f32 v96, v96, v213
    v_sub_f32 v97, v97, v213
    s_waitcnt lgkmcnt(6)
    v_mfma_f32_16x16x32_bf16 v[108:111], v[56:59], v[8:11], v[192:195]
    v_sub_f32 v98, v98, v213
    v_sub_f32 v99, v99, v213
    v_sub_f32 v100, v100, v213
    v_mfma_f32_16x16x32_bf16 v[116:119], v[56:59], v[24:27], v[196:199]
    v_sub_f32 v101, v101, v213
    v_sub_f32 v102, v102, v213
    v_sub_f32 v103, v103, v213
    s_waitcnt lgkmcnt(5)
    v_mfma_f32_16x16x32_bf16 v[104:107], v[44:47], v[12:15], v[104:107]
    v_exp_f32 v88, v88
    v_exp_f32 v89, v89
    v_mfma_f32_16x16x32_bf16 v[112:115], v[44:47], v[28:31], v[112:115]
    v_exp_f32 v90, v90
    s_waitcnt lgkmcnt(4)
    v_mfma_f32_16x16x32_bf16 v[108:111], v[60:63], v[12:15], v[108:111]
    v_cvt_pk_bf16_f32 v120, v88, v89
    v_exp_f32 v91, v91
    v_mfma_f32_16x16x32_bf16 v[116:119], v[60:63], v[28:31], v[116:119]
    v_exp_f32 v92, v92
    v_cvt_pk_bf16_f32 v121, v90, v91
    s_waitcnt lgkmcnt(3)
    v_mfma_f32_16x16x32_bf16 v[104:107], v[48:51], v[16:19], v[104:107]
    v_exp_f32 v93, v93
    v_exp_f32 v94, v94
    v_mfma_f32_16x16x32_bf16 v[112:115], v[48:51], v[32:35], v[112:115]
    v_cvt_pk_bf16_f32 v122, v92, v93
    v_exp_f32 v95, v95
    s_waitcnt lgkmcnt(2)
    v_mfma_f32_16x16x32_bf16 v[108:111], v[64:67], v[16:19], v[108:111]
    v_exp_f32 v96, v96
    v_mfma_f32_16x16x32_bf16 v[116:119], v[64:67], v[32:35], v[116:119]
    v_cvt_pk_bf16_f32 v123, v94, v95
    v_exp_f32 v97, v97
    s_waitcnt lgkmcnt(1)
    v_mfma_f32_16x16x32_bf16 v[104:107], v[52:55], v[20:23], v[104:107]
    v_exp_f32 v98, v98
    v_cvt_pk_bf16_f32 v124, v96, v97
    v_mfma_f32_16x16x32_bf16 v[112:115], v[52:55], v[36:39], v[112:115]
    v_exp_f32 v99, v99
    v_exp_f32 v100, v100
    s_waitcnt lgkmcnt(0)
    v_mfma_f32_16x16x32_bf16 v[108:111], v[68:71], v[20:23], v[108:111]
    v_cvt_pk_bf16_f32 v125, v98, v99
    v_exp_f32 v101, v101
    v_mfma_f32_16x16x32_bf16 v[116:119], v[68:71], v[36:39], v[116:119]
    v_exp_f32 v102, v102
    v_cvt_pk_bf16_f32 v126, v100, v101
    v_exp_f32 v103, v103
    s_nop 0
    v_cvt_pk_bf16_f32 v127, v102, v103
    s_waitcnt lgkmcnt(0)
    s_barrier
    ds_read_b128 v[40:43], v204 offset:32768
    ds_read_b128 v[56:59], v204 offset:36864
    ds_read_b128 v[44:47], v205 offset:32768
    ds_read_b128 v[60:63], v205 offset:36864
    s_nop 1
    ds_read_b128 v[48:51], v206 offset:32768
    v_max3_f32 v212, v104, v105, v106
    v_max3_f32 v213, v112, v113, v114
    ds_read_b128 v[64:67], v206 offset:36864
    v_max3_f32 v212, v212, v107, v108
    v_max3_f32 v213, v213, v115, v116
    ds_read_b128 v[52:55], v207 offset:32768
    v_max3_f32 v212, v212, v109, v110
    v_max3_f32 v213, v213, v117, v118
    ds_read_b128 v[68:71], v207 offset:36864
    v_max3_f32 v214, v212, v111, v119
    v_max_f32 v214, v214, v213
    v_cmp_lt_f32 vcc, s33, v214
    s_cbranch_vccnz L_raP1
L_rabP1:
    v_mfma_f32_16x16x32_bf16 v[184:187], v[200:203], v[120:123], v[184:187]
    v_exp_f32 v104, v104
    v_exp_f32 v105, v105
    v_mfma_f32_16x16x32_bf16 v[188:191], v[200:203], v[124:127], v[188:191]
    v_exp_f32 v106, v106
    s_waitcnt lgkmcnt(7)
    v_mfma_f32_16x16x32_bf16 v[88:91], v[40:43], v[8:11], v[192:195]
    v_cvt_pk_bf16_f32 v128, v104, v105
    v_mfma_f32_16x16x32_bf16 v[96:99], v[40:43], v[24:27], v[196:199]
    v_exp_f32 v107, v107
    s_waitcnt lgkmcnt(6)
    v_mfma_f32_16x16x32_bf16 v[92:95], v[56:59], v[8:11], v[192:195]
    v_exp_f32 v108, v108
    v_mfma_f32_16x16x32_bf16 v[100:103], v[56:59], v[24:27], v[196:199]
    v_cvt_pk_bf16_f32 v129, v106, v107
    v_exp_f32 v109, v109
    s_waitcnt lgkmcnt(5)
    v_mfma_f32_16x16x32_bf16 v[88:91], v[44:47], v[12:15], v[88:91]
    v_exp_f32 v110, v110
    v_mfma_f32_16x16x32_bf16 v[96:99], v[44:47], v[28:31], v[96:99]
    v_cvt_pk_bf16_f32 v130, v108, v109
    s_waitcnt lgkmcnt(4)
    v_mfma_f32_16x16x32_bf16 v[92:95], v[60:63], v[12:15], v[92:95]
    v_exp_f32 v111, v111
    v_mfma_f32_16x16x32_bf16 v[100:103], v[60:63], v[28:31], v[100:103]
    v_exp_f32 v112, v112
    s_waitcnt lgkmcnt(3)
    v_mfma_f32_16x16x32_bf16 v[88:91], v[48:51], v[16:19], v[88:91]
    v_cvt_pk_bf16_f32 v131, v110, v111
    v_exp_f32 v113, v113
    v_mfma_f32_16x16x32_bf16 v[96:99], v[48:51], v[32:35], v[96:99]
    v_exp_f32 v114, v114
    s_waitcnt lgkmcnt(2)
    v_mfma_f32_16x16x32_bf16 v[92:95], v[64:67], v[16:19], v[92:95]
    v_cvt_pk_bf16_f32 v132, v112, v113
    v_mfma_f32_16x16x32_bf16 v[100:103], v[64:67], v[32:35], v[100:103]
    v_exp_f32 v115, v115
    s_waitcnt lgkmcnt(1)
    v_mfma_f32_16x16x32_bf16 v[88:91], v[52:55], v[20:23], v[88:91]
    v_exp_f32 v116, v116
    v_mfma_f32_16x16x32_bf16 v[96:99], v[52:55], v[36:39], v[96:99]
    v_cvt_pk_bf16_f32 v133, v114, v115
    v_exp_f32 v117, v117
    s_waitcnt lgkmcnt(0)
    v_mfma_f32_16x16x32_bf16 v[92:95], v[68:71], v[20:23], v[92:95]
    v_exp_f32 v118, v118
    v_mfma_f32_16x16x32_bf16 v[100:103], v[68:71], v[36:39], v[100:103]
    v_cvt_pk_bf16_f32 v134, v116, v117
    v_exp_f32 v119, v119
    s_nop 0
    v_cvt_pk_bf16_f32 v135, v118, v119
    s_waitcnt lgkmcnt(0)
    s_barrier
    ds_read_b128 v[40:43], v204 offset:49152
    ds_read_b128 v[56:59], v204 offset:53248
    ds_read_b128 v[44:47], v205 offset:49152
    ds_read_b128 v[60:63], v205 offset:53248
    s_nop 1
    ds_read_b128 v[48:51], v206 offset:49152
    v_max3_f32 v212, v88, v89, v90
    v_max3_f32 v213, v96, v97, v98
    ds_read_b128 v[64:67], v206 offset:53248
    v_max3_f32 v212, v212, v91, v92
    v_max3_f32 v213, v213, v99, v100
    ds_read_b128 v[52:55], v207 offset:49152
    v_max3_f32 v212, v212, v93, v94
    v_max3_f32 v213, v213, v101, v102
    ds_read_b128 v[68:71], v207 offset:53248
    v_max3_f32 v214, v212, v95, v103
    v_max_f32 v214, v214, v213
    v_cmp_lt_f32 vcc, s33, v214
    s_cbranch_vccnz L_raP2
L_rabP2:
    v_mfma_f32_16x16x32_bf16 v[184:187], v[200:203], v[128:131], v[184:187]
    v_exp_f32 v88, v88
    v_exp_f32 v89, v89
    v_mfma_f32_16x16x32_bf16 v[188:191], v[200:203], v[132:135], v[188:191]
    v_exp_f32 v90, v90
    s_waitcnt lgkmcnt(7)
    v_mfma_f32_16x16x32_bf16 v[104:107], v[40:43], v[8:11], v[192:195]
    v_cvt_pk_bf16_f32 v136, v88, v89
    v_mfma_f32_16x16x32_bf16 v[112:115], v[40:43], v[24:27], v[196:199]
    v_exp_f32 v91, v91
    s_waitcnt lgkmcnt(6)
    v_mfma_f32_16x16x32_bf16 v[108:111], v[56:59], v[8:11], v[192:195]
    v_exp_f32 v92, v92
    v_mfma_f32_16x16x32_bf16 v[116:119], v[56:59], v[24:27], v[196:199]
    v_cvt_pk_bf16_f32 v137, v90, v91
    v_exp_f32 v93, v93
    s_waitcnt lgkmcnt(5)
    v_mfma_f32_16x16x32_bf16 v[104:107], v[44:47], v[12:15], v[104:107]
    v_exp_f32 v94, v94
    v_mfma_f32_16x16x32_bf16 v[112:115], v[44:47], v[28:31], v[112:115]
    v_cvt_pk_bf16_f32 v138, v92, v93
    s_waitcnt lgkmcnt(4)
    v_mfma_f32_16x16x32_bf16 v[108:111], v[60:63], v[12:15], v[108:111]
    v_exp_f32 v95, v95
    v_mfma_f32_16x16x32_bf16 v[116:119], v[60:63], v[28:31], v[116:119]
    v_exp_f32 v96, v96
    s_waitcnt lgkmcnt(3)
    v_mfma_f32_16x16x32_bf16 v[104:107], v[48:51], v[16:19], v[104:107]
    v_cvt_pk_bf16_f32 v139, v94, v95
    v_exp_f32 v97, v97
    v_mfma_f32_16x16x32_bf16 v[112:115], v[48:51], v[32:35], v[112:115]
    v_exp_f32 v98, v98
    s_waitcnt lgkmcnt(2)
    v_mfma_f32_16x16x32_bf16 v[108:111], v[64:67], v[16:19], v[108:111]
    v_cvt_pk_bf16_f32 v140, v96, v97
    v_mfma_f32_16x16x32_bf16 v[116:119], v[64:67], v[32:35], v[116:119]
    v_exp_f32 v99, v99
    s_waitcnt lgkmcnt(1)
    v_mfma_f32_16x16x32_bf16 v[104:107], v[52:55], v[20:23], v[104:107]
    v_exp_f32 v100, v100
    v_mfma_f32_16x16x32_bf16 v[112:115], v[52:55], v[36:39], v[112:115]
    v_cvt_pk_bf16_f32 v141, v98, v99
    v_exp_f32 v101, v101
    s_waitcnt lgkmcnt(0)
    v_mfma_f32_16x16x32_bf16 v[108:111], v[68:71], v[20:23], v[108:111]
    v_exp_f32 v102, v102
    v_mfma_f32_16x16x32_bf16 v[116:119], v[68:71], v[36:39], v[116:119]
    v_cvt_pk_bf16_f32 v142, v100, v101
    v_exp_f32 v103, v103
    s_nop 0
    v_cvt_pk_bf16_f32 v143, v102, v103
L_loop:
    s_waitcnt lgkmcnt(0)
    s_barrier
    ds_read_b128 v[40:43], v204 offset:0
    ds_read_b128 v[56:59], v204 offset:4096
    ds_read_b128 v[44:47], v205 offset:0
    ds_read_b128 v[60:63], v205 offset:4096
    ds_read_b128 v[48:51], v206 offset:0
    v_max3_f32 v212, v104, v105, v106
    v_max3_f32 v213, v112, v113, v114
    ds_read_b128 v[64:67], v206 offset:4096
    v_max3_f32 v212, v212, v107, v108
    v_max3_f32 v213, v213, v115, v116
    ds_read_b128 v[52:55], v207 offset:0
    v_max3_f32 v212, v212, v109, v110
    v_max3_f32 v213, v213, v117, v118
    ds_read_b128 v[68:71], v207 offset:4096
    v_max3_f32 v214, v212, v111, v119
    v_max_f32 v214, v214, v213
    v_cmp_lt_f32 vcc, s33, v214
    s_cbranch_vccnz L_raK0
L_rabK0:
    v_mfma_f32_16x16x32_bf16 v[184:187], v[200:203], v[136:139], v[184:187]
    ds_read_b64_tr_b16 v[72:73], v208 offset:0
    v_exp_f32 v104, v104
    v_mfma_f32_16x16x32_bf16 v[188:191], v[200:203], v[140:143], v[188:191]
    v_exp_f32 v105, v105
    s_waitcnt lgkmcnt(8)
    v_mfma_f32_16x16x32_bf16 v[88:91], v[40:43], v[8:11], v[192:195]
    ds_read_b64_tr_b16 v[74:75], v208 offset:2048
    v_mfma_f32_16x16x32_bf16 v[96:99], v[40:43], v[24:27], v[196:199]
    v_exp_f32 v106, v106
    s_waitcnt lgkmcnt(8)
    v_mfma_f32_16x16x32_bf16 v[92:95], v[56:59], v[8:11], v[192:195]
    ds_read_b64_tr_b16 v[76:77], v209 offset:0
    v_cvt_pk_bf16_f32 v144, v104, v105
    v_mfma_f32_16x16x32_bf16 v[100:103], v[56:59], v[24:27], v[196:199]
    v_exp_f32 v107, v107
    s_waitcnt lgkmcnt(8)
    v_mfma_f32_16x16x32_bf16 v[88:91], v[44:47], v[12:15], v[88:91]
    ds_read_b64_tr_b16 v[78:79], v209 offset:2048
    v_exp_f32 v108, v108
    v_mfma_f32_16x16x32_bf16 v[96:99], v[44:47], v[28:31], v[96:99]
    ds_read_b64_tr_b16 v[80:81], v210 offset:0
    s_waitcnt lgkmcnt(9)
    v_mfma_f32_16x16x32_bf16 v[92:95], v[60:63], v[12:15], v[92:95]
    v_cvt_pk_bf16_f32 v145, v106, v107
    v_mfma_f32_16x16x32_bf16 v[100:103], v[60:63], v[28:31], v[100:103]
    v_exp_f32 v109, v109
    s_waitcnt lgkmcnt(8)
    v_mfma_f32_16x16x32_bf16 v[88:91], v[48:51], v[16:19], v[88:91]
    ds_read_b64_tr_b16 v[82:83], v210 offset:2048
    v_exp_f32 v110, v110
    v_mfma_f32_16x16x32_bf16 v[96:99], v[48:51], v[32:35], v[96:99]
    ds_read_b64_tr_b16 v[84:85], v211 offset:0
    s_waitcnt lgkmcnt(9)
    v_mfma_f32_16x16x32_bf16 v[92:95], v[64:67], v[16:19], v[92:95]
    v_cvt_pk_bf16_f32 v146, v108, v109
    v_exp_f32 v111, v111
    v_mfma_f32_16x16x32_bf16 v[100:103], v[64:67], v[32:35], v[100:103]
    ds_read_b64_tr_b16 v[86:87], v211 offset:2048
    s_waitcnt lgkmcnt(9)
    v_mfma_f32_16x16x32_bf16 v[88:91], v[52:55], v[20:23], v[88:91]
    v_exp_f32 v112, v112
    v_mfma_f32_16x16x32_bf16 v[96:99], v[52:55], v[36:39], v[96:99]
    v_cvt_pk_bf16_f32 v147, v110, v111
    v_exp_f32 v113, v113
    s_waitcnt lgkmcnt(8)
    v_mfma_f32_16x16x32_bf16 v[92:95], v[68:71], v[20:23], v[92:95]
    v_exp_f32 v114, v114
    v_mfma_f32_16x16x32_bf16 v[100:103], v[68:71], v[36:39], v[100:103]
    s_waitcnt lgkmcnt(6)
    v_mfma_f32_16x16x32_bf16 v[152:155], v[72:75], v[120:123], v[152:155]
    v_cvt_pk_bf16_f32 v148, v112, v113
    v_exp_f32 v115, v115
    v_mfma_f32_16x16x32_bf16 v[156:159], v[72:75], v[124:127], v[156:159]
    v_exp_f32 v116, v116
    s_waitcnt lgkmcnt(4)
    v_mfma_f32_16x16x32_bf16 v[160:163], v[76:79], v[120:123], v[160:163]
    v_cvt_pk_bf16_f32 v149, v114, v115
    v_mfma_f32_16x16x32_bf16 v[164:167], v[76:79], v[124:127], v[164:167]
    v_exp_f32 v117, v117
    s_waitcnt lgkmcnt(2)
    v_mfma_f32_16x16x32_bf16 v[168:171], v[80:83], v[120:123], v[168:171]
    v_exp_f32 v118, v118
    v_mfma_f32_16x16x32_bf16 v[172:175], v[80:83], v[124:127], v[172:175]
    v_cvt_pk_bf16_f32 v150, v116, v117
    v_exp_f32 v119, v119
    s_waitcnt lgkmcnt(0)
    v_mfma_f32_16x16x32_bf16 v[176:179], v[84:87], v[120:123], v[176:179]
    s_nop 0
    v_mfma_f32_16x16x32_bf16 v[180:183], v[84:87], v[124:127], v[180:183]
    v_cvt_pk_bf16_f32 v151, v118, v119
    s_waitcnt lgkmcnt(0)
    s_barrier
    ds_read_b128 v[40:43], v204 offset:16384
    ds_read_b128 v[56:59], v204 offset:20480
    ds_read_b128 v[44:47], v205 offset:16384
    ds_read_b128 v[60:63], v205 offset:20480
    ds_read_b128 v[48:51], v206 offset:16384
    v_max3_f32 v212, v88, v89, v90
    v_max3_f32 v213, v96, v97, v98
    ds_read_b128 v[64:67], v206 offset:20480
    v_max3_f32 v212, v212, v91, v92
    v_max3_f32 v213, v213, v99, v100
    ds_read_b128 v[52:55], v207 offset:16384
    v_max3_f32 v212, v212, v93, v94
    v_max3_f32 v213, v213, v101, v102
    ds_read_b128 v[68:71], v207 offset:20480
    v_max3_f32 v214, v212, v95, v103
    v_max_f32 v214, v214, v213
    v_cmp_lt_f32 vcc, s33, v214
    s_cbranch_vccnz L_raK1
L_rabK1:
    v_mfma_f32_16x16x32_bf16 v[184:187], v[200:203], v[144:147], v[184:187]
    ds_read_b64_tr_b16 v[72:73], v208 offset:8192
    v_exp_f32 v88, v88
    v_mfma_f32_16x16x32_bf16 v[188:191], v[200:203], v[148:151], v[188:191]
    v_exp_f32 v89, v89
    s_waitcnt lgkmcnt(8)
    v_mfma_f32_16x16x32_bf16 v[104:107], v[40:43], v[8:11], v[192:195]
    ds_read_b64_tr_b16 v[74:75], v208 offset:10240
    v_mfma_f32_16x16x32_bf16 v[112:115], v[40:43], v[24:27], v[196:199]
    v_exp_f32 v90, v90
    s_waitcnt lgkmcnt(8)
    v_mfma_f32_16x16x32_bf16 v[108:111], v[56:59], v[8:11], v[192:195]
    ds_read_b64_tr_b16 v[76:77], v209 offset:8192
    v_cvt_pk_bf16_f32 v120, v88, v89
    v_mfma_f32_16x16x32_bf16 v[116:119], v[56:59], v[24:27], v[196:199]
    v_exp_f32 v91, v91
    s_waitcnt lgkmcnt(8)
    v_mfma_f32_16x16x32_bf16 v[104:107], v[44:47], v[12:15], v[104:107]
    ds_read_b64_tr_b16 v[78:79], v209 offset:10240
    v_exp_f32 v92, v92
    v_mfma_f32_16x16x32_bf16 v[112:115], v[44:47], v[28:31], v[112:115]
    ds_read_b64_tr_b16 v[80:81], v210 offset:8192
    s_waitcnt lgkmcnt(9)
    v_mfma_f32_16x16x32_bf16 v[108:111], v[60:63], v[12:15], v[108:111]
    v_cvt_pk_bf16_f32 v121, v90, v91
    v_mfma_f32_16x16x32_bf16 v[116:119], v[60:63], v[28:31], v[116:119]
    v_exp_f32 v93, v93
    s_waitcnt lgkmcnt(8)
    v_mfma_f32_16x16x32_bf16 v[104:107], v[48:51], v[16:19], v[104:107]
    ds_read_b64_tr_b16 v[82:83], v210 offset:10240
    v_exp_f32 v94, v94
    v_mfma_f32_16x16x32_bf16 v[112:115], v[48:51], v[32:35], v[112:115]
    ds_read_b64_tr_b16 v[84:85], v211 offset:8192
    s_waitcnt lgkmcnt(9)
    v_mfma_f32_16x16x32_bf16 v[108:111], v[64:67], v[16:19], v[108:111]
    v_cvt_pk_bf16_f32 v122, v92, v93
    v_exp_f32 v95, v95
    v_mfma_f32_16x16x32_bf16 v[116:119], v[64:67], v[32:35], v[116:119]
    ds_read_b64_tr_b16 v[86:87], v211 offset:10240
    s_waitcnt lgkmcnt(9)
    v_mfma_f32_16x16x32_bf16 v[104:107], v[52:55], v[20:23], v[104:107]
    v_exp_f32 v96, v96
    v_mfma_f32_16x16x32_bf16 v[112:115], v[52:55], v[36:39], v[112:115]
    v_cvt_pk_bf16_f32 v123, v94, v95
    v_exp_f32 v97, v97
    s_waitcnt lgkmcnt(8)
    v_mfma_f32_16x16x32_bf16 v[108:111], v[68:71], v[20:23], v[108:111]
    v_exp_f32 v98, v98
    v_mfma_f32_16x16x32_bf16 v[116:119], v[68:71], v[36:39], v[116:119]
    s_waitcnt lgkmcnt(6)
    v_mfma_f32_16x16x32_bf16 v[152:155], v[72:75], v[128:131], v[152:155]
    v_cvt_pk_bf16_f32 v124, v96, v97
    v_exp_f32 v99, v99
    v_mfma_f32_16x16x32_bf16 v[156:159], v[72:75], v[132:135], v[156:159]
    v_exp_f32 v100, v100
    s_waitcnt lgkmcnt(4)
    v_mfma_f32_16x16x32_bf16 v[160:163], v[76:79], v[128:131], v[160:163]
    v_cvt_pk_bf16_f32 v125, v98, v99
    v_mfma_f32_16x16x32_bf16 v[164:167], v[76:79], v[132:135], v[164:167]
    v_exp_f32 v101, v101
    s_waitcnt lgkmcnt(2)
    v_mfma_f32_16x16x32_bf16 v[168:171], v[80:83], v[128:131], v[168:171]
    v_exp_f32 v102, v102
    v_mfma_f32_16x16x32_bf16 v[172:175], v[80:83], v[132:135], v[172:175]
    v_cvt_pk_bf16_f32 v126, v100, v101
    v_exp_f32 v103, v103
    s_waitcnt lgkmcnt(0)
    v_mfma_f32_16x16x32_bf16 v[176:179], v[84:87], v[128:131], v[176:179]
    s_nop 0
    v_mfma_f32_16x16x32_bf16 v[180:183], v[84:87], v[132:135], v[180:183]
    v_cvt_pk_bf16_f32 v127, v102, v103
    s_waitcnt lgkmcnt(0)
    s_barrier
    ds_read_b128 v[40:43], v204 offset:32768
    ds_read_b128 v[56:59], v204 offset:36864
    ds_read_b128 v[44:47], v205 offset:32768
    ds_read_b128 v[60:63], v205 offset:36864
    ds_read_b128 v[48:51], v206 offset:32768
    v_max3_f32 v212, v104, v105, v106
    v_max3_f32 v213, v112, v113, v114
    ds_read_b128 v[64:67], v206 offset:36864
    v_max3_f32 v212, v212, v107, v108
    v_max3_f32 v213, v213, v115, v116
    ds_read_b128 v[52:55], v207 offset:32768
    v_max3_f32 v212, v212, v109, v110
    v_max3_f32 v213, v213, v117, v118
    ds_read_b128 v[68:71], v207 offset:36864
    v_max3_f32 v214, v212, v111, v119
    v_max_f32 v214, v214, v213
    v_cmp_lt_f32 vcc, s33, v214
    s_cbranch_vccnz L_raK2
L_rabK2:
    v_mfma_f32_16x16x32_bf16 v[184:187], v[200:203], v[120:123], v[184:187]
    ds_read_b64_tr_b16 v[72:73], v208 offset:16384
    v_exp_f32 v104, v104
    v_mfma_f32_16x16x32_bf16 v[188:191], v[200:203], v[124:127], v[188:191]
    v_exp_f32 v105, v105
    s_waitcnt lgkmcnt(8)
    v_mfma_f32_16x16x32_bf16 v[88:91], v[40:43], v[8:11], v[192:195]
    ds_read_b64_tr_b16 v[74:75], v208 offset:18432
    v_mfma_f32_16x16x32_bf16 v[96:99], v[40:43], v[24:27], v[196:199]
    v_exp_f32 v106, v106
    s_waitcnt lgkmcnt(8)
    v_mfma_f32_16x16x32_bf16 v[92:95], v[56:59], v[8:11], v[192:195]
    ds_read_b64_tr_b16 v[76:77], v209 offset:16384
    v_cvt_pk_bf16_f32 v128, v104, v105
    v_mfma_f32_16x16x32_bf16 v[100:103], v[56:59], v[24:27], v[196:199]
    v_exp_f32 v107, v107
    s_waitcnt lgkmcnt(8)
    v_mfma_f32_16x16x32_bf16 v[88:91], v[44:47], v[12:15], v[88:91]
    ds_read_b64_tr_b16 v[78:79], v209 offset:18432
    v_exp_f32 v108, v108
    v_mfma_f32_16x16x32_bf16 v[96:99], v[44:47], v[28:31], v[96:99]
    ds_read_b64_tr_b16 v[80:81], v210 offset:16384
    s_waitcnt lgkmcnt(9)
    v_mfma_f32_16x16x32_bf16 v[92:95], v[60:63], v[12:15], v[92:95]
    v_cvt_pk_bf16_f32 v129, v106, v107
    v_mfma_f32_16x16x32_bf16 v[100:103], v[60:63], v[28:31], v[100:103]
    v_exp_f32 v109, v109
    s_waitcnt lgkmcnt(8)
    v_mfma_f32_16x16x32_bf16 v[88:91], v[48:51], v[16:19], v[88:91]
    ds_read_b64_tr_b16 v[82:83], v210 offset:18432
    v_exp_f32 v110, v110
    v_mfma_f32_16x16x32_bf16 v[96:99], v[48:51], v[32:35], v[96:99]
    ds_read_b64_tr_b16 v[84:85], v211 offset:16384
    s_waitcnt lgkmcnt(9)
    v_mfma_f32_16x16x32_bf16 v[92:95], v[64:67], v[16:19], v[92:95]
    v_cvt_pk_bf16_f32 v130, v108, v109
    v_exp_f32 v111, v111
    v_mfma_f32_16x16x32_bf16 v[100:103], v[64:67], v[32:35], v[100:103]
    ds_read_b64_tr_b16 v[86:87], v211 offset:18432
    s_waitcnt lgkmcnt(9)
    v_mfma_f32_16x16x32_bf16 v[88:91], v[52:55], v[20:23], v[88:91]
    v_exp_f32 v112, v112
    v_mfma_f32_16x16x32_bf16 v[96:99], v[52:55], v[36:39], v[96:99]
    v_cvt_pk_bf16_f32 v131, v110, v111
    v_exp_f32 v113, v113
    s_waitcnt lgkmcnt(8)
    v_mfma_f32_16x16x32_bf16 v[92:95], v[68:71], v[20:23], v[92:95]
    v_exp_f32 v114, v114
    v_mfma_f32_16x16x32_bf16 v[100:103], v[68:71], v[36:39], v[100:103]
    s_waitcnt lgkmcnt(6)
    v_mfma_f32_16x16x32_bf16 v[152:155], v[72:75], v[136:139], v[152:155]
    v_cvt_pk_bf16_f32 v132, v112, v113
    v_exp_f32 v115, v115
    v_mfma_f32_16x16x32_bf16 v[156:159], v[72:75], v[140:143], v[156:159]
    v_exp_f32 v116, v116
    s_waitcnt lgkmcnt(4)
    v_mfma_f32_16x16x32_bf16 v[160:163], v[76:79], v[136:139], v[160:163]
    v_cvt_pk_bf16_f32 v133, v114, v115
    v_mfma_f32_16x16x32_bf16 v[164:167], v[76:79], v[140:143], v[164:167]
    v_exp_f32 v117, v117
    s_waitcnt lgkmcnt(2)
    v_mfma_f32_16x16x32_bf16 v[168:171], v[80:83], v[136:139], v[168:171]
    v_exp_f32 v118, v118
    v_mfma_f32_16x16x32_bf16 v[172:175], v[80:83], v[140:143], v[172:175]
    v_cvt_pk_bf16_f32 v134, v116, v117
    v_exp_f32 v119, v119
    s_waitcnt lgkmcnt(0)
    v_mfma_f32_16x16x32_bf16 v[176:179], v[84:87], v[136:139], v[176:179]
    s_nop 0
    v_mfma_f32_16x16x32_bf16 v[180:183], v[84:87], v[140:143], v[180:183]
    v_cvt_pk_bf16_f32 v135, v118, v119
    s_waitcnt lgkmcnt(0)
    s_barrier
    ds_read_b128 v[40:43], v204 offset:49152
    ds_read_b128 v[56:59], v204 offset:53248
    ds_read_b128 v[44:47], v205 offset:49152
    ds_read_b128 v[60:63], v205 offset:53248
    ds_read_b128 v[48:51], v206 offset:49152
    v_max3_f32 v212, v88, v89, v90
    v_max3_f32 v213, v96, v97, v98
    ds_read_b128 v[64:67], v206 offset:53248
    v_max3_f32 v212, v212, v91, v92
    v_max3_f32 v213, v213, v99, v100
    ds_read_b128 v[52:55], v207 offset:49152
    v_max3_f32 v212, v212, v93, v94
    v_max3_f32 v213, v213, v101, v102
    ds_read_b128 v[68:71], v207 offset:53248
    v_max3_f32 v214, v212, v95, v103
    v_max_f32 v214, v214, v213
    v_cmp_lt_f32 vcc, s33, v214
    s_cbranch_vccnz L_raK3
L_rabK3:
    v_mfma_f32_16x16x32_bf16 v[184:187], v[200:203], v[128:131], v[184:187]
    ds_read_b64_tr_b16 v[72:73], v208 offset:24576
    v_exp_f32 v88, v88
    v_mfma_f32_16x16x32_bf16 v[188:191], v[200:203], v[132:135], v[188:191]
    v_exp_f32 v89, v89
    s_waitcnt lgkmcnt(8)
    v_mfma_f32_16x16x32_bf16 v[104:107], v[40:43], v[8:11], v[192:195]
    ds_read_b64_tr_b16 v[74:75], v208 offset:26624
    v_exp_f32 v90, v90
    v_mfma_f32_16x16x32_bf16 v[112:115], v[40:43], v[24:27], v[196:199]
    ds_read_b64_tr_b16 v[76:77], v209 offset:24576
    s_waitcnt lgkmcnt(9)
    v_mfma_f32_16x16x32_bf16 v[108:111], v[56:59], v[8:11], v[192:195]
    v_cvt_pk_bf16_f32 v136, v88, v89
    v_exp_f32 v91, v91
    v_mfma_f32_16x16x32_bf16 v[116:119], v[56:59], v[24:27], v[196:199]
    ds_read_b64_tr_b16 v[78:79], v209 offset:26624
    s_waitcnt lgkmcnt(9)
    v_mfma_f32_16x16x32_bf16 v[104:107], v[44:47], v[12:15], v[104:107]
    v_exp_f32 v92, v92
    v_mfma_f32_16x16x32_bf16 v[112:115], v[44:47], v[28:31], v[112:115]
    v_cvt_pk_bf16_f32 v137, v90, v91
    ds_read_b64_tr_b16 v[80:81], v210 offset:24576
    s_waitcnt lgkmcnt(9)
    v_mfma_f32_16x16x32_bf16 v[108:111], v[60:63], v[12:15], v[108:111]
    v_exp_f32 v93, v93
    v_mfma_f32_16x16x32_bf16 v[116:119], v[60:63], v[28:31], v[116:119]
    v_exp_f32 v94, v94
    s_waitcnt lgkmcnt(8)
    v_mfma_f32_16x16x32_bf16 v[104:107], v[48:51], v[16:19], v[104:107]
    ds_read_b64_tr_b16 v[82:83], v210 offset:26624
    v_cvt_pk_bf16_f32 v138, v92, v93
    v_mfma_f32_16x16x32_bf16 v[112:115], v[48:51], v[32:35], v[112:115]
    ds_read_b64_tr_b16 v[84:85], v211 offset:24576
    v_exp_f32 v95, v95
    s_waitcnt lgkmcnt(9)
    v_mfma_f32_16x16x32_bf16 v[108:111], v[64:67], v[16:19], v[108:111]
    v_exp_f32 v96, v96
    v_mfma_f32_16x16x32_bf16 v[116:119], v[64:67], v[32:35], v[116:119]
    ds_read_b64_tr_b16 v[86:87], v211 offset:26624
    s_waitcnt lgkmcnt(9)
    v_mfma_f32_16x16x32_bf16 v[104:107], v[52:55], v[20:23], v[104:107]
    v_cvt_pk_bf16_f32 v139, v94, v95
    v_exp_f32 v97, v97
    v_mfma_f32_16x16x32_bf16 v[112:115], v[52:55], v[36:39], v[112:115]
    v_exp_f32 v98, v98
    s_waitcnt lgkmcnt(8)
    v_mfma_f32_16x16x32_bf16 v[108:111], v[68:71], v[20:23], v[108:111]
    v_cvt_pk_bf16_f32 v140, v96, v97
    v_mfma_f32_16x16x32_bf16 v[116:119], v[68:71], v[36:39], v[116:119]
    v_exp_f32 v99, v99
    s_waitcnt lgkmcnt(6)
    v_mfma_f32_16x16x32_bf16 v[152:155], v[72:75], v[144:147], v[152:155]
    v_exp_f32 v100, v100
    v_mfma_f32_16x16x32_bf16 v[156:159], v[72:75], v[148:151], v[156:159]
    v_cvt_pk_bf16_f32 v141, v98, v99
    v_exp_f32 v101, v101
    s_waitcnt lgkmcnt(4)
    v_mfma_f32_16x16x32_bf16 v[160:163], v[76:79], v[144:147], v[160:163]
    v_exp_f32 v102, v102
    v_mfma_f32_16x16x32_bf16 v[164:167], v[76:79], v[148:151], v[164:167]
    v_cvt_pk_bf16_f32 v142, v100, v101
    s_waitcnt lgkmcnt(2)
    v_mfma_f32_16x16x32_bf16 v[168:171], v[80:83], v[144:147], v[168:171]
    v_exp_f32 v103, v103
    v_mfma_f32_16x16x32_bf16 v[172:175], v[80:83], v[148:151], v[172:175]
    s_nop 0
    v_cvt_pk_bf16_f32 v143, v102, v103
    s_waitcnt lgkmcnt(0)
    v_mfma_f32_16x16x32_bf16 v[176:179], v[84:87], v[144:147], v[176:179]
    v_xor_b32 v208, 32768, v208
    v_xor_b32 v209, 32768, v209
    v_mfma_f32_16x16x32_bf16 v[180:183], v[84:87], v[148:151], v[180:183]
    v_xor_b32 v210, 32768, v210
    v_xor_b32 v211, 32768, v211
    s_add_u32 s32, s32, 1
    s_cmp_lt_u32 s32, 7
    s_cbranch_scc1 L_loop
L_exit:
    v_max3_f32 v212, v104, v105, v106
    v_max3_f32 v213, v112, v113, v114
    v_max3_f32 v212, v212, v107, v108
    v_max3_f32 v213, v213, v115, v116
    v_max3_f32 v212, v212, v109, v110
    v_max3_f32 v213, v213, v117, v118
    v_max3_f32 v214, v212, v111, v119
    v_max_f32 v214, v214, v213
    v_cmp_lt_f32 vcc, s33, v214
    s_cbranch_vccnz L_raS31
L_rabS31:
    v_mfma_f32_16x16x32_bf16 v[184:187], v[200:203], v[136:139], v[184:187]
    v_mfma_f32_16x16x32_bf16 v[188:191], v[200:203], v[140:143], v[188:191]
    v_exp_f32 v104, v104
    v_exp_f32 v105, v105
    ds_write_b128 v1, v[136:139] offset:0
    v_exp_f32 v106, v106
    v_cvt_pk_bf16_f32 v144, v104, v105
    v_exp_f32 v107, v107
    v_exp_f32 v108, v108
    v_cvt_pk_bf16_f32 v145, v106, v107
    ds_write_b128 v1, v[140:143] offset:1024
    v_exp_f32 v109, v109
    v_exp_f32 v110, v110
    v_cvt_pk_bf16_f32 v146, v108, v109
    v_exp_f32 v111, v111
    v_exp_f32 v112, v112
    v_cvt_pk_bf16_f32 v147, v110, v111
    v_exp_f32 v113, v113
    v_exp_f32 v114, v114
    v_mfma_f32_16x16x32_bf16 v[184:187], v[200:203], v[144:147], v[184:187]
    ds_write_b128 v1, v[144:147] offset:2048
    v_cvt_pk_bf16_f32 v148, v112, v113
    v_exp_f32 v115, v115
    v_exp_f32 v116, v116
    v_cvt_pk_bf16_f32 v149, v114, v115
    v_exp_f32 v117, v117
    v_exp_f32 v118, v118
    v_cvt_pk_bf16_f32 v150, v116, v117
    v_exp_f32 v119, v119
    v_mov_b32 v96, v192
    v_cvt_pk_bf16_f32 v151, v118, v119
    v_mov_b32 v97, v196
    s_nop 0
    v_mfma_f32_16x16x32_bf16 v[188:191], v[200:203], v[148:151], v[188:191]
    ds_write_b128 v1, v[148:151] offset:3072
    s_barrier
    ds_read_b64_tr_b16 v[80:81], v210 offset:0
    ds_read_b64_tr_b16 v[82:83], v210 offset:2048
    ds_read_b64_tr_b16 v[84:85], v211 offset:0
    ds_read_b64_tr_b16 v[86:87], v211 offset:2048
    ds_read_b64_tr_b16 v[48:49], v210 offset:8192
    ds_read_b64_tr_b16 v[50:51], v210 offset:10240
    ds_read_b64_tr_b16 v[52:53], v211 offset:8192
    ds_read_b64_tr_b16 v[54:55], v211 offset:10240
    v_mov_b32 v98, v184
    v_mov_b32 v99, v188
    s_waitcnt lgkmcnt(6)
    v_mfma_f32_16x16x32_bf16 v[168:171], v[80:83], v[120:123], v[168:171]
    ds_read_b64_tr_b16 v[72:73], v208 offset:0
    ds_read_b64_tr_b16 v[74:75], v208 offset:2048
    v_mfma_f32_16x16x32_bf16 v[172:175], v[80:83], v[124:127], v[172:175]
    ds_read_b64_tr_b16 v[76:77], v209 offset:0
    s_waitcnt lgkmcnt(7)
    v_mfma_f32_16x16x32_bf16 v[176:179], v[84:87], v[120:123], v[176:179]
    ds_read_b64_tr_b16 v[78:79], v209 offset:2048
    v_mfma_f32_16x16x32_bf16 v[180:183], v[84:87], v[124:127], v[180:183]
    ds_read_b64_tr_b16 v[40:41], v208 offset:8192
    s_waitcnt lgkmcnt(7)
    v_mfma_f32_16x16x32_bf16 v[168:171], v[48:51], v[128:131], v[168:171]
    ds_read_b64_tr_b16 v[42:43], v208 offset:10240
    v_mfma_f32_16x16x32_bf16 v[172:175], v[48:51], v[132:135], v[172:175]
    ds_read_b64_tr_b16 v[44:45], v209 offset:8192
    s_waitcnt lgkmcnt(7)
    v_mfma_f32_16x16x32_bf16 v[176:179], v[52:55], v[128:131], v[176:179]
    ds_read_b64_tr_b16 v[46:47], v209 offset:10240
    v_mfma_f32_16x16x32_bf16 v[180:183], v[52:55], v[132:135], v[180:183]
    ds_write_b128 v1, v[96:99] offset:16384
    v_xor_b32 v210, 4096, v208
    v_xor_b32 v211, 4096, v209
    s_waitcnt lgkmcnt(7)
    v_mfma_f32_16x16x32_bf16 v[152:155], v[72:75], v[120:123], v[152:155]
    v_mfma_f32_16x16x32_bf16 v[156:159], v[72:75], v[124:127], v[156:159]
    s_waitcnt lgkmcnt(5)
    v_mfma_f32_16x16x32_bf16 v[160:163], v[76:79], v[120:123], v[160:163]
    ds_write_b128 v218, v[168:171] offset:0
    v_mfma_f32_16x16x32_bf16 v[164:167], v[76:79], v[124:127], v[164:167]
    ds_write_b128 v218, v[172:175] offset:1024
    s_waitcnt lgkmcnt(5)
    v_mfma_f32_16x16x32_bf16 v[152:155], v[40:43], v[128:131], v[152:155]
    v_mfma_f32_16x16x32_bf16 v[156:159], v[40:43], v[132:135], v[156:159]
    ds_write_b128 v218, v[176:179] offset:2048
    s_waitcnt lgkmcnt(4)
    v_mfma_f32_16x16x32_bf16 v[160:163], v[44:47], v[128:131], v[160:163]
    ds_write_b128 v218, v[180:183] offset:3072
    v_mfma_f32_16x16x32_bf16 v[164:167], v[44:47], v[132:135], v[164:167]
    s_waitcnt lgkmcnt(0)
    s_barrier
    ds_read_b64_tr_b16 v[72:73], v208 offset:16384
    ds_read_b64_tr_b16 v[74:75], v208 offset:18432
    ds_read_b64_tr_b16 v[76:77], v209 offset:16384
    ds_read_b64_tr_b16 v[78:79], v209 offset:18432
    ds_read_b64_tr_b16 v[40:41], v208 offset:24576
    ds_read_b64_tr_b16 v[42:43], v208 offset:26624
    ds_read_b64_tr_b16 v[44:45], v209 offset:24576
    ds_read_b64_tr_b16 v[46:47], v209 offset:26624
    ds_read_b128 v[100:103], v7 offset:16384
    ds_read_b128 v[120:123], v7 offset:0
    ds_read_b128 v[124:127], v7 offset:1024
    ds_read_b64_tr_b16 v[80:81], v210 offset:16384
    ds_read_b64_tr_b16 v[82:83], v210 offset:18432
    s_waitcnt lgkmcnt(11)
    v_mfma_f32_16x16x32_bf16 v[152:155], v[72:75], v[136:139], v[152:155]
    ds_read_b128 v[168:171], v219 offset:0
    ds_read_b128 v[172:175], v219 offset:1024
    v_mfma_f32_16x16x32_bf16 v[156:159], v[72:75], v[140:143], v[156:159]
    ds_read_b64_tr_b16 v[84:85], v211 offset:16384
    s_waitcnt lgkmcnt(12)
    v_mfma_f32_16x16x32_bf16 v[160:163], v[76:79], v[136:139], v[160:163]
    ds_read_b64_tr_b16 v[86:87], v211 offset:18432
    ds_read_b128 v[176:179], v219 offset:2048
    v_mfma_f32_16x16x32_bf16 v[164:167], v[76:79], v[140:143], v[164:167]
    ds_read_b128 v[180:183], v219 offset:3072
    s_waitcnt lgkmcnt(13)
    v_mfma_f32_16x16x32_bf16 v[152:155], v[40:43], v[144:147], v[152:155]
    ds_read_b128 v[128:131], v7 offset:2048
    ds_read_b128 v[132:135], v7 offset:3072
    v_mfma_f32_16x16x32_bf16 v[156:159], v[40:43], v[148:151], v[156:159]
    ds_read_b64_tr_b16 v[48:49], v210 offset:24576
    s_waitcnt lgkmcnt(14)
    v_mfma_f32_16x16x32_bf16 v[160:163], v[44:47], v[144:147], v[160:163]
    ds_read_b64_tr_b16 v[50:51], v210 offset:26624
    ds_read_b64_tr_b16 v[52:53], v211 offset:24576
    v_mfma_f32_16x16x32_bf16 v[164:167], v[44:47], v[148:151], v[164:167]
    ds_read_b64_tr_b16 v[54:55], v211 offset:26624
    s_waitcnt lgkmcnt(11)
    v_mfma_f32_16x16x32_bf16 v[168:171], v[80:83], v[120:123], v[168:171]
    v_min_f32 v216, v96, v100
    v_sub_f32 v212, v216, v96
    v_sub_f32 v214, v216, v100
    s_waitcnt lgkmcnt(10)
    v_mfma_f32_16x16x32_bf16 v[172:175], v[80:83], v[124:127], v[172:175]
    v_exp_f32 v212, v212
    v_exp_f32 v214, v214
    s_waitcnt lgkmcnt(7)
    v_mfma_f32_16x16x32_bf16 v[176:179], v[84:87], v[120:123], v[176:179]
    v_min_f32 v216, v97, v101
    v_sub_f32 v213, v216, v97
    s_waitcnt lgkmcnt(6)
    v_mfma_f32_16x16x32_bf16 v[180:183], v[84:87], v[124:127], v[180:183]
    v_sub_f32 v215, v216, v101
    v_exp_f32 v213, v213
    s_waitcnt lgkmcnt(2)
    v_mfma_f32_16x16x32_bf16 v[168:171], v[48:51], v[128:131], v[168:171]
    v_exp_f32 v215, v215
    v_mul_f32 v216, v212, v98
    v_mfma_f32_16x16x32_bf16 v[172:175], v[48:51], v[132:135], v[172:175]
    v_fmac_f32 v216, v214, v102
    v_rcp_f32 v216, v216
    s_waitcnt lgkmcnt(0)
    v_mfma_f32_16x16x32_bf16 v[176:179], v[52:55], v[128:131], v[176:179]
    v_mul_f32 v217, v213, v99
    v_fmac_f32 v217, v215, v103
    v_rcp_f32 v217, v217
    v_mfma_f32_16x16x32_bf16 v[180:183], v[52:55], v[132:135], v[180:183]
    s_nop 0
    v_mul_f32 v212, v216, v212
    v_mul_f32 v214, v216, v214
    v_mul_f32 v213, v217, v213
    v_mul_f32 v215, v217, v215
    v_mul_f32 v152, v212, v152
    v_mul_f32 v153, v212, v153
    v_mul_f32 v154, v212, v154
    v_mul_f32 v155, v212, v155
    v_mul_f32 v160, v212, v160
    v_mul_f32 v161, v212, v161
    v_mul_f32 v162, v212, v162
    v_mul_f32 v163, v212, v163
    v_fmac_f32 v152, v214, v168
    v_fmac_f32 v153, v214, v169
    v_fmac_f32 v154, v214, v170
    v_fmac_f32 v155, v214, v171
    v_cvt_pk_bf16_f32 v88, v152, v153
    v_cvt_pk_bf16_f32 v89, v154, v155
    v_fmac_f32 v160, v214, v176
    v_fmac_f32 v161, v214, v177
    v_fmac_f32 v162, v214, v178
    v_fmac_f32 v163, v214, v179
    v_cvt_pk_bf16_f32 v90, v160, v161
    v_cvt_pk_bf16_f32 v91, v162, v163
    s_nop 1
    v_permlane16_swap_b32 v88, v90
    v_permlane16_swap_b32 v89, v91
    buffer_store_dwordx4 v[88:91], v6, s[12:15], 0 offen
    v_mul_f32 v156, v213, v156
    v_mul_f32 v157, v213, v157
    v_mul_f32 v158, v213, v158
    v_mul_f32 v159, v213, v159
    v_mul_f32 v164, v213, v164
    v_mul_f32 v165, v213, v165
    v_mul_f32 v166, v213, v166
    v_mul_f32 v167, v213, v167
    v_fmac_f32 v156, v215, v172
    v_fmac_f32 v157, v215, v173
    v_fmac_f32 v158, v215, v174
    v_fmac_f32 v159, v215, v175
    v_cvt_pk_bf16_f32 v92, v156, v157
    v_cvt_pk_bf16_f32 v93, v158, v159
    v_fmac_f32 v164, v215, v180
    v_fmac_f32 v165, v215, v181
    v_fmac_f32 v166, v215, v182
    v_fmac_f32 v167, v215, v183
    v_cvt_pk_bf16_f32 v94, v164, v165
    v_cvt_pk_bf16_f32 v95, v166, v167
    s_nop 1
    v_permlane16_swap_b32 v92, v94
    v_permlane16_swap_b32 v93, v95
    buffer_store_dwordx4 v[92:95], v6, s[12:15], s28 offen
L_end:
    s_endpgm
L_raP1:
    s_nop 7
    v_max_f32 v212, v212, v111
    v_max_f32 v213, v213, v119
    v_mov_b32 v214, v212
    v_mov_b32 v215, v213
    s_nop 1
    v_permlane32_swap_b32 v212, v214
    v_permlane32_swap_b32 v213, v215
    v_max_f32 v212, v212, v214
    v_max_f32 v213, v213, v215
    v_mov_b32 v214, v212
    v_mov_b32 v215, v213
    s_nop 1
    v_permlane16_swap_b32 v212, v214
    v_permlane16_swap_b32 v213, v215
    v_max_f32 v212, v212, v214
    v_max_f32 v213, v213, v215
    v_max_f32 v212, 0, v212
    v_ceil_f32 v212, v212
    v_sub_f32 v214, 0, v212
    v_exp_f32 v214, v214
    v_sub_f32 v192, v192, v212
    v_sub_f32 v193, v193, v212
    v_sub_f32 v194, v194, v212
    v_sub_f32 v195, v195, v212
    v_sub_f32 v104, v104, v212
    v_sub_f32 v105, v105, v212
    v_sub_f32 v106, v106, v212
    v_sub_f32 v107, v107, v212
    v_sub_f32 v108, v108, v212
    v_sub_f32 v109, v109, v212
    v_sub_f32 v110, v110, v212
    v_sub_f32 v111, v111, v212
    v_mul_f32 v152, v214, v152
    v_mul_f32 v153, v214, v153
    v_mul_f32 v154, v214, v154
    v_mul_f32 v155, v214, v155
    v_mul_f32 v160, v214, v160
    v_mul_f32 v161, v214, v161
    v_mul_f32 v162, v214, v162
    v_mul_f32 v163, v214, v163
    v_mul_f32 v168, v214, v168
    v_mul_f32 v169, v214, v169
    v_mul_f32 v170, v214, v170
    v_mul_f32 v171, v214, v171
    v_mul_f32 v176, v214, v176
    v_mul_f32 v177, v214, v177
    v_mul_f32 v178, v214, v178
    v_mul_f32 v179, v214, v179
    v_mul_f32 v184, v214, v184
    v_lshlrev_b32 v216, 16, v120
    v_and_b32 v217, 0xffff0000, v120
    v_mul_f32 v216, v214, v216
    v_mul_f32 v217, v214, v217
    v_cvt_pk_bf16_f32 v120, v216, v217
    v_lshlrev_b32 v216, 16, v121
    v_and_b32 v217, 0xffff0000, v121
    v_mul_f32 v216, v214, v216
    v_mul_f32 v217, v214, v217
    v_cvt_pk_bf16_f32 v121, v216, v217
    v_lshlrev_b32 v216, 16, v122
    v_and_b32 v217, 0xffff0000, v122
    v_mul_f32 v216, v214, v216
    v_mul_f32 v217, v214, v217
    v_cvt_pk_bf16_f32 v122, v216, v217
    v_lshlrev_b32 v216, 16, v123
    v_and_b32 v217, 0xffff0000, v123
    v_mul_f32 v216, v214, v216
    v_mul_f32 v217, v214, v217
    v_cvt_pk_bf16_f32 v123, v216, v217
    v_lshlrev_b32 v216, 16, v144
    v_and_b32 v217, 0xffff0000, v144
    v_mul_f32 v216, v214, v216
    v_mul_f32 v217, v214, v217
    v_cvt_pk_bf16_f32 v144, v216, v217
    v_lshlrev_b32 v216, 16, v145
    v_and_b32 v217, 0xffff0000, v145
    v_mul_f32 v216, v214, v216
    v_mul_f32 v217, v214, v217
    v_cvt_pk_bf16_f32 v145, v216, v217
    v_lshlrev_b32 v216, 16, v146
    v_and_b32 v217, 0xffff0000, v146
    v_mul_f32 v216, v214, v216
    v_mul_f32 v217, v214, v217
    v_cvt_pk_bf16_f32 v146, v216, v217
    v_lshlrev_b32 v216, 16, v147
    v_and_b32 v217, 0xffff0000, v147
    v_mul_f32 v216, v214, v216
    v_mul_f32 v217, v214, v217
    v_cvt_pk_bf16_f32 v147, v216, v217
    v_lshlrev_b32 v216, 16, v136
    v_and_b32 v217, 0xffff0000, v136
    v_mul_f32 v216, v214, v216
    v_mul_f32 v217, v214, v217
    v_cvt_pk_bf16_f32 v136, v216, v217
    v_lshlrev_b32 v216, 16, v137
    v_and_b32 v217, 0xffff0000, v137
    v_mul_f32 v216, v214, v216
    v_mul_f32 v217, v214, v217
    v_cvt_pk_bf16_f32 v137, v216, v217
    v_lshlrev_b32 v216, 16, v138
    v_and_b32 v217, 0xffff0000, v138
    v_mul_f32 v216, v214, v216
    v_mul_f32 v217, v214, v217
    v_cvt_pk_bf16_f32 v138, v216, v217
    v_lshlrev_b32 v216, 16, v139
    v_and_b32 v217, 0xffff0000, v139
    v_mul_f32 v216, v214, v216
    v_mul_f32 v217, v214, v217
    v_cvt_pk_bf16_f32 v139, v216, v217
    v_max_f32 v213, 0, v213
    v_ceil_f32 v213, v213
    v_sub_f32 v214, 0, v213
    v_exp_f32 v214, v214
    v_sub_f32 v196, v196, v213
    v_sub_f32 v197, v197, v213
    v_sub_f32 v198, v198, v213
    v_sub_f32 v199, v199, v213
    v_sub_f32 v112, v112, v213
    v_sub_f32 v113, v113, v213
    v_sub_f32 v114, v114, v213
    v_sub_f32 v115, v115, v213
    v_sub_f32 v116, v116, v213
    v_sub_f32 v117, v117, v213
    v_sub_f32 v118, v118, v213
    v_sub_f32 v119, v119, v213
    v_mul_f32 v156, v214, v156
    v_mul_f32 v157, v214, v157
    v_mul_f32 v158, v214, v158
    v_mul_f32 v159, v214, v159
    v_mul_f32 v164, v214, v164
    v_mul_f32 v165, v214, v165
    v_mul_f32 v166, v214, v166
    v_mul_f32 v167, v214, v167
    v_mul_f32 v172, v214, v172
    v_mul_f32 v173, v214, v173
    v_mul_f32 v174, v214, v174
    v_mul_f32 v175, v214, v175
    v_mul_f32 v180, v214, v180
    v_mul_f32 v181, v214, v181
    v_mul_f32 v182, v214, v182
    v_mul_f32 v183, v214, v183
    v_mul_f32 v188, v214, v188
    v_lshlrev_b32 v216, 16, v124
    v_and_b32 v217, 0xffff0000, v124
    v_mul_f32 v216, v214, v216
    v_mul_f32 v217, v214, v217
    v_cvt_pk_bf16_f32 v124, v216, v217
    v_lshlrev_b32 v216, 16, v125
    v_and_b32 v217, 0xffff0000, v125
    v_mul_f32 v216, v214, v216
    v_mul_f32 v217, v214, v217
    v_cvt_pk_bf16_f32 v125, v216, v217
    v_lshlrev_b32 v216, 16, v126
    v_and_b32 v217, 0xffff0000, v126
    v_mul_f32 v216, v214, v216
    v_mul_f32 v217, v214, v217
    v_cvt_pk_bf16_f32 v126, v216, v217
    v_lshlrev_b32 v216, 16, v127
    v_and_b32 v217, 0xffff0000, v127
    v_mul_f32 v216, v214, v216
    v_mul_f32 v217, v214, v217
    v_cvt_pk_bf16_f32 v127, v216, v217
    v_lshlrev_b32 v216, 16, v148
    v_and_b32 v217, 0xffff0000, v148
    v_mul_f32 v216, v214, v216
    v_mul_f32 v217, v214, v217
    v_cvt_pk_bf16_f32 v148, v216, v217
    v_lshlrev_b32 v216, 16, v149
    v_and_b32 v217, 0xffff0000, v149
    v_mul_f32 v216, v214, v216
    v_mul_f32 v217, v214, v217
    v_cvt_pk_bf16_f32 v149, v216, v217
    v_lshlrev_b32 v216, 16, v150
    v_and_b32 v217, 0xffff0000, v150
    v_mul_f32 v216, v214, v216
    v_mul_f32 v217, v214, v217
    v_cvt_pk_bf16_f32 v150, v216, v217
    v_lshlrev_b32 v216, 16, v151
    v_and_b32 v217, 0xffff0000, v151
    v_mul_f32 v216, v214, v216
    v_mul_f32 v217, v214, v217
    v_cvt_pk_bf16_f32 v151, v216, v217
    v_lshlrev_b32 v216, 16, v140
    v_and_b32 v217, 0xffff0000, v140
    v_mul_f32 v216, v214, v216
    v_mul_f32 v217, v214, v217
    v_cvt_pk_bf16_f32 v140, v216, v217
    v_lshlrev_b32 v216, 16, v141
    v_and_b32 v217, 0xffff0000, v141
    v_mul_f32 v216, v214, v216
    v_mul_f32 v217, v214, v217
    v_cvt_pk_bf16_f32 v141, v216, v217
    v_lshlrev_b32 v216, 16, v142
    v_and_b32 v217, 0xffff0000, v142
    v_mul_f32 v216, v214, v216
    v_mul_f32 v217, v214, v217
    v_cvt_pk_bf16_f32 v142, v216, v217
    v_lshlrev_b32 v216, 16, v143
    v_and_b32 v217, 0xffff0000, v143
    v_mul_f32 v216, v214, v216
    v_mul_f32 v217, v214, v217
    v_cvt_pk_bf16_f32 v143, v216, v217
    s_nop 1
    s_branch L_rabP1
L_raP2:
    s_nop 7
    v_max_f32 v212, v212, v95
    v_max_f32 v213, v213, v103
    v_mov_b32 v214, v212
    v_mov_b32 v215, v213
    s_nop 1
    v_permlane32_swap_b32 v212, v214
    v_permlane32_swap_b32 v213, v215
    v_max_f32 v212, v212, v214
    v_max_f32 v213, v213, v215
    v_mov_b32 v214, v212
    v_mov_b32 v215, v213
    s_nop 1
    v_permlane16_swap_b32 v212, v214
    v_permlane16_swap_b32 v213, v215
    v_max_f32 v212, v212, v214
    v_max_f32 v213, v213, v215
    v_max_f32 v212, 0, v212
    v_ceil_f32 v212, v212
    v_sub_f32 v214, 0, v212
    v_exp_f32 v214, v214
    v_sub_f32 v192, v192, v212
    v_sub_f32 v193, v193, v212
    v_sub_f32 v194, v194, v212
    v_sub_f32 v195, v195, v212
    v_sub_f32 v88, v88, v212
    v_sub_f32 v89, v89, v212
    v_sub_f32 v90, v90, v212
    v_sub_f32 v91, v91, v212
    v_sub_f32 v92, v92, v212
    v_sub_f32 v93, v93, v212
    v_sub_f32 v94, v94, v212
    v_sub_f32 v95, v95, v212
    v_mul_f32 v152, v214, v152
    v_mul_f32 v153, v214, v153
    v_mul_f32 v154, v214, v154
    v_mul_f32 v155, v214, v155
    v_mul_f32 v160, v214, v160
    v_mul_f32 v161, v214, v161
    v_mul_f32 v162, v214, v162
    v_mul_f32 v163, v214, v163
    v_mul_f32 v168, v214, v168
    v_mul_f32 v169, v214, v169
    v_mul_f32 v170, v214, v170
    v_mul_f32 v171, v214, v171
    v_mul_f32 v176, v214, v176
    v_mul_f32 v177, v214, v177
    v_mul_f32 v178, v214, v178
    v_mul_f32 v179, v214, v179
    v_mul_f32 v184, v214, v184
    v_lshlrev_b32 v216, 16, v128
    v_and_b32 v217, 0xffff0000, v128
    v_mul_f32 v216, v214, v216
    v_mul_f32 v217, v214, v217
    v_cvt_pk_bf16_f32 v128, v216, v217
    v_lshlrev_b32 v216, 16, v129
    v_and_b32 v217, 0xffff0000, v129
    v_mul_f32 v216, v214, v216
    v_mul_f32 v217, v214, v217
    v_cvt_pk_bf16_f32 v129, v216, v217
    v_lshlrev_b32 v216, 16, v130
    v_and_b32 v217, 0xffff0000, v130
    v_mul_f32 v216, v214, v216
    v_mul_f32 v217, v214, v217
    v_cvt_pk_bf16_f32 v130, v216, v217
    v_lshlrev_b32 v216, 16, v131
    v_and_b32 v217, 0xffff0000, v131
    v_mul_f32 v216, v214, v216
    v_mul_f32 v217, v214, v217
    v_cvt_pk_bf16_f32 v131, v216, v217
    v_lshlrev_b32 v216, 16, v120
    v_and_b32 v217, 0xffff0000, v120
    v_mul_f32 v216, v214, v216
    v_mul_f32 v217, v214, v217
    v_cvt_pk_bf16_f32 v120, v216, v217
    v_lshlrev_b32 v216, 16, v121
    v_and_b32 v217, 0xffff0000, v121
    v_mul_f32 v216, v214, v216
    v_mul_f32 v217, v214, v217
    v_cvt_pk_bf16_f32 v121, v216, v217
    v_lshlrev_b32 v216, 16, v122
    v_and_b32 v217, 0xffff0000, v122
    v_mul_f32 v216, v214, v216
    v_mul_f32 v217, v214, v217
    v_cvt_pk_bf16_f32 v122, v216, v217
    v_lshlrev_b32 v216, 16, v123
    v_and_b32 v217, 0xffff0000, v123
    v_mul_f32 v216, v214, v216
    v_mul_f32 v217, v214, v217
    v_cvt_pk_bf16_f32 v123, v216, v217
    v_lshlrev_b32 v216, 16, v144
    v_and_b32 v217, 0xffff0000, v144
    v_mul_f32 v216, v214, v216
    v_mul_f32 v217, v214, v217
    v_cvt_pk_bf16_f32 v144, v216, v217
    v_lshlrev_b32 v216, 16, v145
    v_and_b32 v217, 0xffff0000, v145
    v_mul_f32 v216, v214, v216
    v_mul_f32 v217, v214, v217
    v_cvt_pk_bf16_f32 v145, v216, v217
    v_lshlrev_b32 v216, 16, v146
    v_and_b32 v217, 0xffff0000, v146
    v_mul_f32 v216, v214, v216
    v_mul_f32 v217, v214, v217
    v_cvt_pk_bf16_f32 v146, v216, v217
    v_lshlrev_b32 v216, 16, v147
    v_and_b32 v217, 0xffff0000, v147
    v_mul_f32 v216, v214, v216
    v_mul_f32 v217, v214, v217
    v_cvt_pk_bf16_f32 v147, v216, v217
    v_max_f32 v213, 0, v213
    v_ceil_f32 v213, v213
    v_sub_f32 v214, 0, v213
    v_exp_f32 v214, v214
    v_sub_f32 v196, v196, v213
    v_sub_f32 v197, v197, v213
    v_sub_f32 v198, v198, v213
    v_sub_f32 v199, v199, v213
    v_sub_f32 v96, v96, v213
    v_sub_f32 v97, v97, v213
    v_sub_f32 v98, v98, v213
    v_sub_f32 v99, v99, v213
    v_sub_f32 v100, v100, v213
    v_sub_f32 v101, v101, v213
    v_sub_f32 v102, v102, v213
    v_sub_f32 v103, v103, v213
    v_mul_f32 v156, v214, v156
    v_mul_f32 v157, v214, v157
    v_mul_f32 v158, v214, v158
    v_mul_f32 v159, v214, v159
    v_mul_f32 v164, v214, v164
    v_mul_f32 v165, v214, v165
    v_mul_f32 v166, v214, v166
    v_mul_f32 v167, v214, v167
    v_mul_f32 v172, v214, v172
    v_mul_f32 v173, v214, v173
    v_mul_f32 v174, v214, v174
    v_mul_f32 v175, v214, v175
    v_mul_f32 v180, v214, v180
    v_mul_f32 v181, v214, v181
    v_mul_f32 v182, v214, v182
    v_mul_f32 v183, v214, v183
    v_mul_f32 v188, v214, v188
    v_lshlrev_b32 v216, 16, v132
    v_and_b32 v217, 0xffff0000, v132
    v_mul_f32 v216, v214, v216
    v_mul_f32 v217, v214, v217
    v_cvt_pk_bf16_f32 v132, v216, v217
    v_lshlrev_b32 v216, 16, v133
    v_and_b32 v217, 0xffff0000, v133
    v_mul_f32 v216, v214, v216
    v_mul_f32 v217, v214, v217
    v_cvt_pk_bf16_f32 v133, v216, v217
    v_lshlrev_b32 v216, 16, v134
    v_and_b32 v217, 0xffff0000, v134
    v_mul_f32 v216, v214, v216
    v_mul_f32 v217, v214, v217
    v_cvt_pk_bf16_f32 v134, v216, v217
    v_lshlrev_b32 v216, 16, v135
    v_and_b32 v217, 0xffff0000, v135
    v_mul_f32 v216, v214, v216
    v_mul_f32 v217, v214, v217
    v_cvt_pk_bf16_f32 v135, v216, v217
    v_lshlrev_b32 v216, 16, v124
    v_and_b32 v217, 0xffff0000, v124
    v_mul_f32 v216, v214, v216
    v_mul_f32 v217, v214, v217
    v_cvt_pk_bf16_f32 v124, v216, v217
    v_lshlrev_b32 v216, 16, v125
    v_and_b32 v217, 0xffff0000, v125
    v_mul_f32 v216, v214, v216
    v_mul_f32 v217, v214, v217
    v_cvt_pk_bf16_f32 v125, v216, v217
    v_lshlrev_b32 v216, 16, v126
    v_and_b32 v217, 0xffff0000, v126
    v_mul_f32 v216, v214, v216
    v_mul_f32 v217, v214, v217
    v_cvt_pk_bf16_f32 v126, v216, v217
    v_lshlrev_b32 v216, 16, v127
    v_and_b32 v217, 0xffff0000, v127
    v_mul_f32 v216, v214, v216
    v_mul_f32 v217, v214, v217
    v_cvt_pk_bf16_f32 v127, v216, v217
    v_lshlrev_b32 v216, 16, v148
    v_and_b32 v217, 0xffff0000, v148
    v_mul_f32 v216, v214, v216
    v_mul_f32 v217, v214, v217
    v_cvt_pk_bf16_f32 v148, v216, v217
    v_lshlrev_b32 v216, 16, v149
    v_and_b32 v217, 0xffff0000, v149
    v_mul_f32 v216, v214, v216
    v_mul_f32 v217, v214, v217
    v_cvt_pk_bf16_f32 v149, v216, v217
    v_lshlrev_b32 v216, 16, v150
    v_and_b32 v217, 0xffff0000, v150
    v_mul_f32 v216, v214, v216
    v_mul_f32 v217, v214, v217
    v_cvt_pk_bf16_f32 v150, v216, v217
    v_lshlrev_b32 v216, 16, v151
    v_and_b32 v217, 0xffff0000, v151
    v_mul_f32 v216, v214, v216
    v_mul_f32 v217, v214, v217
    v_cvt_pk_bf16_f32 v151, v216, v217
    s_nop 1
    s_branch L_rabP2
L_raK0:
    s_nop 7
    v_max_f32 v212, v212, v111
    v_max_f32 v213, v213, v119
    v_mov_b32 v214, v212
    v_mov_b32 v215, v213
    s_nop 1
    v_permlane32_swap_b32 v212, v214
    v_permlane32_swap_b32 v213, v215
    v_max_f32 v212, v212, v214
    v_max_f32 v213, v213, v215
    v_mov_b32 v214, v212
    v_mov_b32 v215, v213
    s_nop 1
    v_permlane16_swap_b32 v212, v214
    v_permlane16_swap_b32 v213, v215
    v_max_f32 v212, v212, v214
    v_max_f32 v213, v213, v215
    v_max_f32 v212, 0, v212
    v_ceil_f32 v212, v212
    v_sub_f32 v214, 0, v212
    v_exp_f32 v214, v214
    v_sub_f32 v192, v192, v212
    v_sub_f32 v193, v193, v212
    v_sub_f32 v194, v194, v212
    v_sub_f32 v195, v195, v212
    v_sub_f32 v104, v104, v212
    v_sub_f32 v105, v105, v212
    v_sub_f32 v106, v106, v212
    v_sub_f32 v107, v107, v212
    v_sub_f32 v108, v108, v212
    v_sub_f32 v109, v109, v212
    v_sub_f32 v110, v110, v212
    v_sub_f32 v111, v111, v212
    v_mul_f32 v152, v214, v152
    v_mul_f32 v153, v214, v153
    v_mul_f32 v154, v214, v154
    v_mul_f32 v155, v214, v155
    v_mul_f32 v160, v214, v160
    v_mul_f32 v161, v214, v161
    v_mul_f32 v162, v214, v162
    v_mul_f32 v163, v214, v163
    v_mul_f32 v168, v214, v168
    v_mul_f32 v169, v214, v169
    v_mul_f32 v170, v214, v170
    v_mul_f32 v171, v214, v171
    v_mul_f32 v176, v214, v176
    v_mul_f32 v177, v214, v177
    v_mul_f32 v178, v214, v178
    v_mul_f32 v179, v214, v179
    v_mul_f32 v184, v214, v184
    v_lshlrev_b32 v216, 16, v136
    v_and_b32 v217, 0xffff0000, v136
    v_mul_f32 v216, v214, v216
    v_mul_f32 v217, v214, v217
    v_cvt_pk_bf16_f32 v136, v216, v217
    v_lshlrev_b32 v216, 16, v137
    v_and_b32 v217, 0xffff0000, v137
    v_mul_f32 v216, v214, v216
    v_mul_f32 v217, v214, v217
    v_cvt_pk_bf16_f32 v137, v216, v217
    v_lshlrev_b32 v216, 16, v138
    v_and_b32 v217, 0xffff0000, v138
    v_mul_f32 v216, v214, v216
    v_mul_f32 v217, v214, v217
    v_cvt_pk_bf16_f32 v138, v216, v217
    v_lshlrev_b32 v216, 16, v139
    v_and_b32 v217, 0xffff0000, v139
    v_mul_f32 v216, v214, v216
    v_mul_f32 v217, v214, v217
    v_cvt_pk_bf16_f32 v139, v216, v217
    v_lshlrev_b32 v216, 16, v128
    v_and_b32 v217, 0xffff0000, v128
    v_mul_f32 v216, v214, v216
    v_mul_f32 v217, v214, v217
    v_cvt_pk_bf16_f32 v128, v216, v217
    v_lshlrev_b32 v216, 16, v129
    v_and_b32 v217, 0xffff0000, v129
    v_mul_f32 v216, v214, v216
    v_mul_f32 v217, v214, v217
    v_cvt_pk_bf16_f32 v129, v216, v217
    v_lshlrev_b32 v216, 16, v130
    v_and_b32 v217, 0xffff0000, v130
    v_mul_f32 v216, v214, v216
    v_mul_f32 v217, v214, v217
    v_cvt_pk_bf16_f32 v130, v216, v217
    v_lshlrev_b32 v216, 16, v131
    v_and_b32 v217, 0xffff0000, v131
    v_mul_f32 v216, v214, v216
    v_mul_f32 v217, v214, v217
    v_cvt_pk_bf16_f32 v131, v216, v217
    v_lshlrev_b32 v216, 16, v120
    v_and_b32 v217, 0xffff0000, v120
    v_mul_f32 v216, v214, v216
    v_mul_f32 v217, v214, v217
    v_cvt_pk_bf16_f32 v120, v216, v217
    v_lshlrev_b32 v216, 16, v121
    v_and_b32 v217, 0xffff0000, v121
    v_mul_f32 v216, v214, v216
    v_mul_f32 v217, v214, v217
    v_cvt_pk_bf16_f32 v121, v216, v217
    v_lshlrev_b32 v216, 16, v122
    v_and_b32 v217, 0xffff0000, v122
    v_mul_f32 v216, v214, v216
    v_mul_f32 v217, v214, v217
    v_cvt_pk_bf16_f32 v122, v216, v217
    v_lshlrev_b32 v216, 16, v123
    v_and_b32 v217, 0xffff0000, v123
    v_mul_f32 v216, v214, v216
    v_mul_f32 v217, v214, v217
    v_cvt_pk_bf16_f32 v123, v216, v217
    v_max_f32 v213, 0, v213
    v_ceil_f32 v213, v213
    v_sub_f32 v214, 0, v213
    v_exp_f32 v214, v214
    v_sub_f32 v196, v196, v213
    v_sub_f32 v197, v197, v213
    v_sub_f32 v198, v198, v213
    v_sub_f32 v199, v199, v213
    v_sub_f32 v112, v112, v213
    v_sub_f32 v113, v113, v213
    v_sub_f32 v114, v114, v213
    v_sub_f32 v115, v115, v213
    v_sub_f32 v116, v116, v213
    v_sub_f32 v117, v117, v213
    v_sub_f32 v118, v118, v213
    v_sub_f32 v119, v119, v213
    v_mul_f32 v156, v214, v156
    v_mul_f32 v157, v214, v157
    v_mul_f32 v158, v214, v158
    v_mul_f32 v159, v214, v159
    v_mul_f32 v164, v214, v164
    v_mul_f32 v165, v214, v165
    v_mul_f32 v166, v214, v166
    v_mul_f32 v167, v214, v167
    v_mul_f32 v172, v214, v172
    v_mul_f32 v173, v214, v173
    v_mul_f32 v174, v214, v174
    v_mul_f32 v175, v214, v175
    v_mul_f32 v180, v214, v180
    v_mul_f32 v181, v214, v181
    v_mul_f32 v182, v214, v182
    v_mul_f32 v183, v214, v183
    v_mul_f32 v188, v214, v188
    v_lshlrev_b32 v216, 16, v140
    v_and_b32 v217, 0xffff0000, v140
    v_mul_f32 v216, v214, v216
    v_mul_f32 v217, v214, v217
    v_cvt_pk_bf16_f32 v140, v216, v217
    v_lshlrev_b32 v216, 16, v141
    v_and_b32 v217, 0xffff0000, v141
    v_mul_f32 v216, v214, v216
    v_mul_f32 v217, v214, v217
    v_cvt_pk_bf16_f32 v141, v216, v217
    v_lshlrev_b32 v216, 16, v142
    v_and_b32 v217, 0xffff0000, v142
    v_mul_f32 v216, v214, v216
    v_mul_f32 v217, v214, v217
    v_cvt_pk_bf16_f32 v142, v216, v217
    v_lshlrev_b32 v216, 16, v143
    v_and_b32 v217, 0xffff0000, v143
    v_mul_f32 v216, v214, v216
    v_mul_f32 v217, v214, v217
    v_cvt_pk_bf16_f32 v143, v216, v217
    v_lshlrev_b32 v216, 16, v132
    v_and_b32 v217, 0xffff0000, v132
    v_mul_f32 v216, v214, v216
    v_mul_f32 v217, v214, v217
    v_cvt_pk_bf16_f32 v132, v216, v217
    v_lshlrev_b32 v216, 16, v133
    v_and_b32 v217, 0xffff0000, v133
    v_mul_f32 v216, v214, v216
    v_mul_f32 v217, v214, v217
    v_cvt_pk_bf16_f32 v133, v216, v217
    v_lshlrev_b32 v216, 16, v134
    v_and_b32 v217, 0xffff0000, v134
    v_mul_f32 v216, v214, v216
    v_mul_f32 v217, v214, v217
    v_cvt_pk_bf16_f32 v134, v216, v217
    v_lshlrev_b32 v216, 16, v135
    v_and_b32 v217, 0xffff0000, v135
    v_mul_f32 v216, v214, v216
    v_mul_f32 v217, v214, v217
    v_cvt_pk_bf16_f32 v135, v216, v217
    v_lshlrev_b32 v216, 16, v124
    v_and_b32 v217, 0xffff0000, v124
    v_mul_f32 v216, v214, v216
    v_mul_f32 v217, v214, v217
    v_cvt_pk_bf16_f32 v124, v216, v217
    v_lshlrev_b32 v216, 16, v125
    v_and_b32 v217, 0xffff0000, v125
    v_mul_f32 v216, v214, v216
    v_mul_f32 v217, v214, v217
    v_cvt_pk_bf16_f32 v125, v216, v217
    v_lshlrev_b32 v216, 16, v126
    v_and_b32 v217, 0xffff0000, v126
    v_mul_f32 v216, v214, v216
    v_mul_f32 v217, v214, v217
    v_cvt_pk_bf16_f32 v126, v216, v217
    v_lshlrev_b32 v216, 16, v127
    v_and_b32 v217, 0xffff0000, v127
    v_mul_f32 v216, v214, v216
    v_mul_f32 v217, v214, v217
    v_cvt_pk_bf16_f32 v127, v216, v217
    s_nop 1
    s_branch L_rabK0
L_raK1:
    s_nop 7
    v_max_f32 v212, v212, v95
    v_max_f32 v213, v213, v103
    v_mov_b32 v214, v212
    v_mov_b32 v215, v213
    s_nop 1
    v_permlane32_swap_b32 v212, v214
    v_permlane32_swap_b32 v213, v215
    v_max_f32 v212, v212, v214
    v_max_f32 v213, v213, v215
    v_mov_b32 v214, v212
    v_mov_b32 v215, v213
    s_nop 1
    v_permlane16_swap_b32 v212, v214
    v_permlane16_swap_b32 v213, v215
    v_max_f32 v212, v212, v214
    v_max_f32 v213, v213, v215
    v_max_f32 v212, 0, v212
    v_ceil_f32 v212, v212
    v_sub_f32 v214, 0, v212
    v_exp_f32 v214, v214
    v_sub_f32 v192, v192, v212
    v_sub_f32 v193, v193, v212
    v_sub_f32 v194, v194, v212
    v_sub_f32 v195, v195, v212
    v_sub_f32 v88, v88, v212
    v_sub_f32 v89, v89, v212
    v_sub_f32 v90, v90, v212
    v_sub_f32 v91, v91, v212
    v_sub_f32 v92, v92, v212
    v_sub_f32 v93, v93, v212
    v_sub_f32 v94, v94, v212
    v_sub_f32 v95, v95, v212
    v_mul_f32 v152, v214, v152
    v_mul_f32 v153, v214, v153
    v_mul_f32 v154, v214, v154
    v_mul_f32 v155, v214, v155
    v_mul_f32 v160, v214, v160
    v_mul_f32 v161, v214, v161
    v_mul_f32 v162, v214, v162
    v_mul_f32 v163, v214, v163
    v_mul_f32 v168, v214, v168
    v_mul_f32 v169, v214, v169
    v_mul_f32 v170, v214, v170
    v_mul_f32 v171, v214, v171
    v_mul_f32 v176, v214, v176
    v_mul_f32 v177, v214, v177
    v_mul_f32 v178, v214, v178
    v_mul_f32 v179, v214, v179
    v_mul_f32 v184, v214, v184
    v_lshlrev_b32 v216, 16, v144
    v_and_b32 v217, 0xffff0000, v144
    v_mul_f32 v216, v214, v216
    v_mul_f32 v217, v214, v217
    v_cvt_pk_bf16_f32 v144, v216, v217
    v_lshlrev_b32 v216, 16, v145
    v_and_b32 v217, 0xffff0000, v145
    v_mul_f32 v216, v214, v216
    v_mul_f32 v217, v214, v217
    v_cvt_pk_bf16_f32 v145, v216, v217
    v_lshlrev_b32 v216, 16, v146
    v_and_b32 v217, 0xffff0000, v146
    v_mul_f32 v216, v214, v216
    v_mul_f32 v217, v214, v217
    v_cvt_pk_bf16_f32 v146, v216, v217
    v_lshlrev_b32 v216, 16, v147
    v_and_b32 v217, 0xffff0000, v147
    v_mul_f32 v216, v214, v216
    v_mul_f32 v217, v214, v217
    v_cvt_pk_bf16_f32 v147, v216, v217
    v_lshlrev_b32 v216, 16, v136
    v_and_b32 v217, 0xffff0000, v136
    v_mul_f32 v216, v214, v216
    v_mul_f32 v217, v214, v217
    v_cvt_pk_bf16_f32 v136, v216, v217
    v_lshlrev_b32 v216, 16, v137
    v_and_b32 v217, 0xffff0000, v137
    v_mul_f32 v216, v214, v216
    v_mul_f32 v217, v214, v217
    v_cvt_pk_bf16_f32 v137, v216, v217
    v_lshlrev_b32 v216, 16, v138
    v_and_b32 v217, 0xffff0000, v138
    v_mul_f32 v216, v214, v216
    v_mul_f32 v217, v214, v217
    v_cvt_pk_bf16_f32 v138, v216, v217
    v_lshlrev_b32 v216, 16, v139
    v_and_b32 v217, 0xffff0000, v139
    v_mul_f32 v216, v214, v216
    v_mul_f32 v217, v214, v217
    v_cvt_pk_bf16_f32 v139, v216, v217
    v_lshlrev_b32 v216, 16, v128
    v_and_b32 v217, 0xffff0000, v128
    v_mul_f32 v216, v214, v216
    v_mul_f32 v217, v214, v217
    v_cvt_pk_bf16_f32 v128, v216, v217
    v_lshlrev_b32 v216, 16, v129
    v_and_b32 v217, 0xffff0000, v129
    v_mul_f32 v216, v214, v216
    v_mul_f32 v217, v214, v217
    v_cvt_pk_bf16_f32 v129, v216, v217
    v_lshlrev_b32 v216, 16, v130
    v_and_b32 v217, 0xffff0000, v130
    v_mul_f32 v216, v214, v216
    v_mul_f32 v217, v214, v217
    v_cvt_pk_bf16_f32 v130, v216, v217
    v_lshlrev_b32 v216, 16, v131
    v_and_b32 v217, 0xffff0000, v131
    v_mul_f32 v216, v214, v216
    v_mul_f32 v217, v214, v217
    v_cvt_pk_bf16_f32 v131, v216, v217
    v_max_f32 v213, 0, v213
    v_ceil_f32 v213, v213
    v_sub_f32 v214, 0, v213
    v_exp_f32 v214, v214
    v_sub_f32 v196, v196, v213
    v_sub_f32 v197, v197, v213
    v_sub_f32 v198, v198, v213
    v_sub_f32 v199, v199, v213
    v_sub_f32 v96, v96, v213
    v_sub_f32 v97, v97, v213
    v_sub_f32 v98, v98, v213
    v_sub_f32 v99, v99, v213
    v_sub_f32 v100, v100, v213
    v_sub_f32 v101, v101, v213
    v_sub_f32 v102, v102, v213
    v_sub_f32 v103, v103, v213
    v_mul_f32 v156, v214, v156
    v_mul_f32 v157, v214, v157
    v_mul_f32 v158, v214, v158
    v_mul_f32 v159, v214, v159
    v_mul_f32 v164, v214, v164
    v_mul_f32 v165, v214, v165
    v_mul_f32 v166, v214, v166
    v_mul_f32 v167, v214, v167
    v_mul_f32 v172, v214, v172
    v_mul_f32 v173, v214, v173
    v_mul_f32 v174, v214, v174
    v_mul_f32 v175, v214, v175
    v_mul_f32 v180, v214, v180
    v_mul_f32 v181, v214, v181
    v_mul_f32 v182, v214, v182
    v_mul_f32 v183, v214, v183
    v_mul_f32 v188, v214, v188
    v_lshlrev_b32 v216, 16, v148
    v_and_b32 v217, 0xffff0000, v148
    v_mul_f32 v216, v214, v216
    v_mul_f32 v217, v214, v217
    v_cvt_pk_bf16_f32 v148, v216, v217
    v_lshlrev_b32 v216, 16, v149
    v_and_b32 v217, 0xffff0000, v149
    v_mul_f32 v216, v214, v216
    v_mul_f32 v217, v214, v217
    v_cvt_pk_bf16_f32 v149, v216, v217
    v_lshlrev_b32 v216, 16, v150
    v_and_b32 v217, 0xffff0000, v150
    v_mul_f32 v216, v214, v216
    v_mul_f32 v217, v214, v217
    v_cvt_pk_bf16_f32 v150, v216, v217
    v_lshlrev_b32 v216, 16, v151
    v_and_b32 v217, 0xffff0000, v151
    v_mul_f32 v216, v214, v216
    v_mul_f32 v217, v214, v217
    v_cvt_pk_bf16_f32 v151, v216, v217
    v_lshlrev_b32 v216, 16, v140
    v_and_b32 v217, 0xffff0000, v140
    v_mul_f32 v216, v214, v216
    v_mul_f32 v217, v214, v217
    v_cvt_pk_bf16_f32 v140, v216, v217
    v_lshlrev_b32 v216, 16, v141
    v_and_b32 v217, 0xffff0000, v141
    v_mul_f32 v216, v214, v216
    v_mul_f32 v217, v214, v217
    v_cvt_pk_bf16_f32 v141, v216, v217
    v_lshlrev_b32 v216, 16, v142
    v_and_b32 v217, 0xffff0000, v142
    v_mul_f32 v216, v214, v216
    v_mul_f32 v217, v214, v217
    v_cvt_pk_bf16_f32 v142, v216, v217
    v_lshlrev_b32 v216, 16, v143
    v_and_b32 v217, 0xffff0000, v143
    v_mul_f32 v216, v214, v216
    v_mul_f32 v217, v214, v217
    v_cvt_pk_bf16_f32 v143, v216, v217
    v_lshlrev_b32 v216, 16, v132
    v_and_b32 v217, 0xffff0000, v132
    v_mul_f32 v216, v214, v216
    v_mul_f32 v217, v214, v217
    v_cvt_pk_bf16_f32 v132, v216, v217
    v_lshlrev_b32 v216, 16, v133
    v_and_b32 v217, 0xffff0000, v133
    v_mul_f32 v216, v214, v216
    v_mul_f32 v217, v214, v217
    v_cvt_pk_bf16_f32 v133, v216, v217
    v_lshlrev_b32 v216, 16, v134
    v_and_b32 v217, 0xffff0000, v134
    v_mul_f32 v216, v214, v216
    v_mul_f32 v217, v214, v217
    v_cvt_pk_bf16_f32 v134, v216, v217
    v_lshlrev_b32 v216, 16, v135
    v_and_b32 v217, 0xffff0000, v135
    v_mul_f32 v216, v214, v216
    v_mul_f32 v217, v214, v217
    v_cvt_pk_bf16_f32 v135, v216, v217
    s_nop 1
    s_branch L_rabK1
L_raK2:
    s_nop 7
    v_max_f32 v212, v212, v111
    v_max_f32 v213, v213, v119
    v_mov_b32 v214, v212
    v_mov_b32 v215, v213
    s_nop 1
    v_permlane32_swap_b32 v212, v214
    v_permlane32_swap_b32 v213, v215
    v_max_f32 v212, v212, v214
    v_max_f32 v213, v213, v215
    v_mov_b32 v214, v212
    v_mov_b32 v215, v213
    s_nop 1
    v_permlane16_swap_b32 v212, v214
    v_permlane16_swap_b32 v213, v215
    v_max_f32 v212, v212, v214
    v_max_f32 v213, v213, v215
    v_max_f32 v212, 0, v212
    v_ceil_f32 v212, v212
    v_sub_f32 v214, 0, v212
    v_exp_f32 v214, v214
    v_sub_f32 v192, v192, v212
    v_sub_f32 v193, v193, v212
    v_sub_f32 v194, v194, v212
    v_sub_f32 v195, v195, v212
    v_sub_f32 v104, v104, v212
    v_sub_f32 v105, v105, v212
    v_sub_f32 v106, v106, v212
    v_sub_f32 v107, v107, v212
    v_sub_f32 v108, v108, v212
    v_sub_f32 v109, v109, v212
    v_sub_f32 v110, v110, v212
    v_sub_f32 v111, v111, v212
    v_mul_f32 v152, v214, v152
    v_mul_f32 v153, v214, v153
    v_mul_f32 v154, v214, v154
    v_mul_f32 v155, v214, v155
    v_mul_f32 v160, v214, v160
    v_mul_f32 v161, v214, v161
    v_mul_f32 v162, v214, v162
    v_mul_f32 v163, v214, v163
    v_mul_f32 v168, v214, v168
    v_mul_f32 v169, v214, v169
    v_mul_f32 v170, v214, v170
    v_mul_f32 v171, v214, v171
    v_mul_f32 v176, v214, v176
    v_mul_f32 v177, v214, v177
    v_mul_f32 v178, v214, v178
    v_mul_f32 v179, v214, v179
    v_mul_f32 v184, v214, v184
    v_lshlrev_b32 v216, 16, v120
    v_and_b32 v217, 0xffff0000, v120
    v_mul_f32 v216, v214, v216
    v_mul_f32 v217, v214, v217
    v_cvt_pk_bf16_f32 v120, v216, v217
    v_lshlrev_b32 v216, 16, v121
    v_and_b32 v217, 0xffff0000, v121
    v_mul_f32 v216, v214, v216
    v_mul_f32 v217, v214, v217
    v_cvt_pk_bf16_f32 v121, v216, v217
    v_lshlrev_b32 v216, 16, v122
    v_and_b32 v217, 0xffff0000, v122
    v_mul_f32 v216, v214, v216
    v_mul_f32 v217, v214, v217
    v_cvt_pk_bf16_f32 v122, v216, v217
    v_lshlrev_b32 v216, 16, v123
    v_and_b32 v217, 0xffff0000, v123
    v_mul_f32 v216, v214, v216
    v_mul_f32 v217, v214, v217
    v_cvt_pk_bf16_f32 v123, v216, v217
    v_lshlrev_b32 v216, 16, v144
    v_and_b32 v217, 0xffff0000, v144
    v_mul_f32 v216, v214, v216
    v_mul_f32 v217, v214, v217
    v_cvt_pk_bf16_f32 v144, v216, v217
    v_lshlrev_b32 v216, 16, v145
    v_and_b32 v217, 0xffff0000, v145
    v_mul_f32 v216, v214, v216
    v_mul_f32 v217, v214, v217
    v_cvt_pk_bf16_f32 v145, v216, v217
    v_lshlrev_b32 v216, 16, v146
    v_and_b32 v217, 0xffff0000, v146
    v_mul_f32 v216, v214, v216
    v_mul_f32 v217, v214, v217
    v_cvt_pk_bf16_f32 v146, v216, v217
    v_lshlrev_b32 v216, 16, v147
    v_and_b32 v217, 0xffff0000, v147
    v_mul_f32 v216, v214, v216
    v_mul_f32 v217, v214, v217
    v_cvt_pk_bf16_f32 v147, v216, v217
    v_lshlrev_b32 v216, 16, v136
    v_and_b32 v217, 0xffff0000, v136
    v_mul_f32 v216, v214, v216
    v_mul_f32 v217, v214, v217
    v_cvt_pk_bf16_f32 v136, v216, v217
    v_lshlrev_b32 v216, 16, v137
    v_and_b32 v217, 0xffff0000, v137
    v_mul_f32 v216, v214, v216
    v_mul_f32 v217, v214, v217
    v_cvt_pk_bf16_f32 v137, v216, v217
    v_lshlrev_b32 v216, 16, v138
    v_and_b32 v217, 0xffff0000, v138
    v_mul_f32 v216, v214, v216
    v_mul_f32 v217, v214, v217
    v_cvt_pk_bf16_f32 v138, v216, v217
    v_lshlrev_b32 v216, 16, v139
    v_and_b32 v217, 0xffff0000, v139
    v_mul_f32 v216, v214, v216
    v_mul_f32 v217, v214, v217
    v_cvt_pk_bf16_f32 v139, v216, v217
    v_max_f32 v213, 0, v213
    v_ceil_f32 v213, v213
    v_sub_f32 v214, 0, v213
    v_exp_f32 v214, v214
    v_sub_f32 v196, v196, v213
    v_sub_f32 v197, v197, v213
    v_sub_f32 v198, v198, v213
    v_sub_f32 v199, v199, v213
    v_sub_f32 v112, v112, v213
    v_sub_f32 v113, v113, v213
    v_sub_f32 v114, v114, v213
    v_sub_f32 v115, v115, v213
    v_sub_f32 v116, v116, v213
    v_sub_f32 v117, v117, v213
    v_sub_f32 v118, v118, v213
    v_sub_f32 v119, v119, v213
    v_mul_f32 v156, v214, v156
    v_mul_f32 v157, v214, v157
    v_mul_f32 v158, v214, v158
    v_mul_f32 v159, v214, v159
    v_mul_f32 v164, v214, v164
    v_mul_f32 v165, v214, v165
    v_mul_f32 v166, v214, v166
    v_mul_f32 v167, v214, v167
    v_mul_f32 v172, v214, v172
    v_mul_f32 v173, v214, v173
    v_mul_f32 v174, v214, v174
    v_mul_f32 v175, v214, v175
    v_mul_f32 v180, v214, v180
    v_mul_f32 v181, v214, v181
    v_mul_f32 v182, v214, v182
    v_mul_f32 v183, v214, v183
    v_mul_f32 v188, v214, v188
    v_lshlrev_b32 v216, 16, v124
    v_and_b32 v217, 0xffff0000, v124
    v_mul_f32 v216, v214, v216
    v_mul_f32 v217, v214, v217
    v_cvt_pk_bf16_f32 v124, v216, v217
    v_lshlrev_b32 v216, 16, v125
    v_and_b32 v217, 0xffff0000, v125
    v_mul_f32 v216, v214, v216
    v_mul_f32 v217, v214, v217
    v_cvt_pk_bf16_f32 v125, v216, v217
    v_lshlrev_b32 v216, 16, v126
    v_and_b32 v217, 0xffff0000, v126
    v_mul_f32 v216, v214, v216
    v_mul_f32 v217, v214, v217
    v_cvt_pk_bf16_f32 v126, v216, v217
    v_lshlrev_b32 v216, 16, v127
    v_and_b32 v217, 0xffff0000, v127
    v_mul_f32 v216, v214, v216
    v_mul_f32 v217, v214, v217
    v_cvt_pk_bf16_f32 v127, v216, v217
    v_lshlrev_b32 v216, 16, v148
    v_and_b32 v217, 0xffff0000, v148
    v_mul_f32 v216, v214, v216
    v_mul_f32 v217, v214, v217
    v_cvt_pk_bf16_f32 v148, v216, v217
    v_lshlrev_b32 v216, 16, v149
    v_and_b32 v217, 0xffff0000, v149
    v_mul_f32 v216, v214, v216
    v_mul_f32 v217, v214, v217
    v_cvt_pk_bf16_f32 v149, v216, v217
    v_lshlrev_b32 v216, 16, v150
    v_and_b32 v217, 0xffff0000, v150
    v_mul_f32 v216, v214, v216
    v_mul_f32 v217, v214, v217
    v_cvt_pk_bf16_f32 v150, v216, v217
    v_lshlrev_b32 v216, 16, v151
    v_and_b32 v217, 0xffff0000, v151
    v_mul_f32 v216, v214, v216
    v_mul_f32 v217, v214, v217
    v_cvt_pk_bf16_f32 v151, v216, v217
    v_lshlrev_b32 v216, 16, v140
    v_and_b32 v217, 0xffff0000, v140
    v_mul_f32 v216, v214, v216
    v_mul_f32 v217, v214, v217
    v_cvt_pk_bf16_f32 v140, v216, v217
    v_lshlrev_b32 v216, 16, v141
    v_and_b32 v217, 0xffff0000, v141
    v_mul_f32 v216, v214, v216
    v_mul_f32 v217, v214, v217
    v_cvt_pk_bf16_f32 v141, v216, v217
    v_lshlrev_b32 v216, 16, v142
    v_and_b32 v217, 0xffff0000, v142
    v_mul_f32 v216, v214, v216
    v_mul_f32 v217, v214, v217
    v_cvt_pk_bf16_f32 v142, v216, v217
    v_lshlrev_b32 v216, 16, v143
    v_and_b32 v217, 0xffff0000, v143
    v_mul_f32 v216, v214, v216
    v_mul_f32 v217, v214, v217
    v_cvt_pk_bf16_f32 v143, v216, v217
    s_nop 1
    s_branch L_rabK2
L_raK3:
    s_nop 7
    v_max_f32 v212, v212, v95
    v_max_f32 v213, v213, v103
    v_mov_b32 v214, v212
    v_mov_b32 v215, v213
    s_nop 1
    v_permlane32_swap_b32 v212, v214
    v_permlane32_swap_b32 v213, v215
    v_max_f32 v212, v212, v214
    v_max_f32 v213, v213, v215
    v_mov_b32 v214, v212
    v_mov_b32 v215, v213
    s_nop 1
    v_permlane16_swap_b32 v212, v214
    v_permlane16_swap_b32 v213, v215
    v_max_f32 v212, v212, v214
    v_max_f32 v213, v213, v215
    v_max_f32 v212, 0, v212
    v_ceil_f32 v212, v212
    v_sub_f32 v214, 0, v212
    v_exp_f32 v214, v214
    v_sub_f32 v192, v192, v212
    v_sub_f32 v193, v193, v212
    v_sub_f32 v194, v194, v212
    v_sub_f32 v195, v195, v212
    v_sub_f32 v88, v88, v212
    v_sub_f32 v89, v89, v212
    v_sub_f32 v90, v90, v212
    v_sub_f32 v91, v91, v212
    v_sub_f32 v92, v92, v212
    v_sub_f32 v93, v93, v212
    v_sub_f32 v94, v94, v212
    v_sub_f32 v95, v95, v212
    v_mul_f32 v152, v214, v152
    v_mul_f32 v153, v214, v153
    v_mul_f32 v154, v214, v154
    v_mul_f32 v155, v214, v155
    v_mul_f32 v160, v214, v160
    v_mul_f32 v161, v214, v161
    v_mul_f32 v162, v214, v162
    v_mul_f32 v163, v214, v163
    v_mul_f32 v168, v214, v168
    v_mul_f32 v169, v214, v169
    v_mul_f32 v170, v214, v170
    v_mul_f32 v171, v214, v171
    v_mul_f32 v176, v214, v176
    v_mul_f32 v177, v214, v177
    v_mul_f32 v178, v214, v178
    v_mul_f32 v179, v214, v179
    v_mul_f32 v184, v214, v184
    v_lshlrev_b32 v216, 16, v128
    v_and_b32 v217, 0xffff0000, v128
    v_mul_f32 v216, v214, v216
    v_mul_f32 v217, v214, v217
    v_cvt_pk_bf16_f32 v128, v216, v217
    v_lshlrev_b32 v216, 16, v129
    v_and_b32 v217, 0xffff0000, v129
    v_mul_f32 v216, v214, v216
    v_mul_f32 v217, v214, v217
    v_cvt_pk_bf16_f32 v129, v216, v217
    v_lshlrev_b32 v216, 16, v130
    v_and_b32 v217, 0xffff0000, v130
    v_mul_f32 v216, v214, v216
    v_mul_f32 v217, v214, v217
    v_cvt_pk_bf16_f32 v130, v216, v217
    v_lshlrev_b32 v216, 16, v131
    v_and_b32 v217, 0xffff0000, v131
    v_mul_f32 v216, v214, v216
    v_mul_f32 v217, v214, v217
    v_cvt_pk_bf16_f32 v131, v216, v217
    v_lshlrev_b32 v216, 16, v120
    v_and_b32 v217, 0xffff0000, v120
    v_mul_f32 v216, v214, v216
    v_mul_f32 v217, v214, v217
    v_cvt_pk_bf16_f32 v120, v216, v217
    v_lshlrev_b32 v216, 16, v121
    v_and_b32 v217, 0xffff0000, v121
    v_mul_f32 v216, v214, v216
    v_mul_f32 v217, v214, v217
    v_cvt_pk_bf16_f32 v121, v216, v217
    v_lshlrev_b32 v216, 16, v122
    v_and_b32 v217, 0xffff0000, v122
    v_mul_f32 v216, v214, v216
    v_mul_f32 v217, v214, v217
    v_cvt_pk_bf16_f32 v122, v216, v217
    v_lshlrev_b32 v216, 16, v123
    v_and_b32 v217, 0xffff0000, v123
    v_mul_f32 v216, v214, v216
    v_mul_f32 v217, v214, v217
    v_cvt_pk_bf16_f32 v123, v216, v217
    v_lshlrev_b32 v216, 16, v144
    v_and_b32 v217, 0xffff0000, v144
    v_mul_f32 v216, v214, v216
    v_mul_f32 v217, v214, v217
    v_cvt_pk_bf16_f32 v144, v216, v217
    v_lshlrev_b32 v216, 16, v145
    v_and_b32 v217, 0xffff0000, v145
    v_mul_f32 v216, v214, v216
    v_mul_f32 v217, v214, v217
    v_cvt_pk_bf16_f32 v145, v216, v217
    v_lshlrev_b32 v216, 16, v146
    v_and_b32 v217, 0xffff0000, v146
    v_mul_f32 v216, v214, v216
    v_mul_f32 v217, v214, v217
    v_cvt_pk_bf16_f32 v146, v216, v217
    v_lshlrev_b32 v216, 16, v147
    v_and_b32 v217, 0xffff0000, v147
    v_mul_f32 v216, v214, v216
    v_mul_f32 v217, v214, v217
    v_cvt_pk_bf16_f32 v147, v216, v217
    v_max_f32 v213, 0, v213
    v_ceil_f32 v213, v213
    v_sub_f32 v214, 0, v213
    v_exp_f32 v214, v214
    v_sub_f32 v196, v196, v213
    v_sub_f32 v197, v197, v213
    v_sub_f32 v198, v198, v213
    v_sub_f32 v199, v199, v213
    v_sub_f32 v96, v96, v213
    v_sub_f32 v97, v97, v213
    v_sub_f32 v98, v98, v213
    v_sub_f32 v99, v99, v213
    v_sub_f32 v100, v100, v213
    v_sub_f32 v101, v101, v213
    v_sub_f32 v102, v102, v213
    v_sub_f32 v103, v103, v213
    v_mul_f32 v156, v214, v156
    v_mul_f32 v157, v214, v157
    v_mul_f32 v158, v214, v158
    v_mul_f32 v159, v214, v159
    v_mul_f32 v164, v214, v164
    v_mul_f32 v165, v214, v165
    v_mul_f32 v166, v214, v166
    v_mul_f32 v167, v214, v167
    v_mul_f32 v172, v214, v172
    v_mul_f32 v173, v214, v173
    v_mul_f32 v174, v214, v174
    v_mul_f32 v175, v214, v175
    v_mul_f32 v180, v214, v180
    v_mul_f32 v181, v214, v181
    v_mul_f32 v182, v214, v182
    v_mul_f32 v183, v214, v183
    v_mul_f32 v188, v214, v188
    v_lshlrev_b32 v216, 16, v132
    v_and_b32 v217, 0xffff0000, v132
    v_mul_f32 v216, v214, v216
    v_mul_f32 v217, v214, v217
    v_cvt_pk_bf16_f32 v132, v216, v217
    v_lshlrev_b32 v216, 16, v133
    v_and_b32 v217, 0xffff0000, v133
    v_mul_f32 v216, v214, v216
    v_mul_f32 v217, v214, v217
    v_cvt_pk_bf16_f32 v133, v216, v217
    v_lshlrev_b32 v216, 16, v134
    v_and_b32 v217, 0xffff0000, v134
    v_mul_f32 v216, v214, v216
    v_mul_f32 v217, v214, v217
    v_cvt_pk_bf16_f32 v134, v216, v217
    v_lshlrev_b32 v216, 16, v135
    v_and_b32 v217, 0xffff0000, v135
    v_mul_f32 v216, v214, v216
    v_mul_f32 v217, v214, v217
    v_cvt_pk_bf16_f32 v135, v216, v217
    v_lshlrev_b32 v216, 16, v124
    v_and_b32 v217, 0xffff0000, v124
    v_mul_f32 v216, v214, v216
    v_mul_f32 v217, v214, v217
    v_cvt_pk_bf16_f32 v124, v216, v217
    v_lshlrev_b32 v216, 16, v125
    v_and_b32 v217, 0xffff0000, v125
    v_mul_f32 v216, v214, v216
    v_mul_f32 v217, v214, v217
    v_cvt_pk_bf16_f32 v125, v216, v217
    v_lshlrev_b32 v216, 16, v126
    v_and_b32 v217, 0xffff0000, v126
    v_mul_f32 v216, v214, v216
    v_mul_f32 v217, v214, v217
    v_cvt_pk_bf16_f32 v126, v216, v217
    v_lshlrev_b32 v216, 16, v127
    v_and_b32 v217, 0xffff0000, v127
    v_mul_f32 v216, v214, v216
    v_mul_f32 v217, v214, v217
    v_cvt_pk_bf16_f32 v127, v216, v217
    v_lshlrev_b32 v216, 16, v148
    v_and_b32 v217, 0xffff0000, v148
    v_mul_f32 v216, v214, v216
    v_mul_f32 v217, v214, v217
    v_cvt_pk_bf16_f32 v148, v216, v217
    v_lshlrev_b32 v216, 16, v149
    v_and_b32 v217, 0xffff0000, v149
    v_mul_f32 v216, v214, v216
    v_mul_f32 v217, v214, v217
    v_cvt_pk_bf16_f32 v149, v216, v217
    v_lshlrev_b32 v216, 16, v150
    v_and_b32 v217, 0xffff0000, v150
    v_mul_f32 v216, v214, v216
    v_mul_f32 v217, v214, v217
    v_cvt_pk_bf16_f32 v150, v216, v217
    v_lshlrev_b32 v216, 16, v151
    v_and_b32 v217, 0xffff0000, v151
    v_mul_f32 v216, v214, v216
    v_mul_f32 v217, v214, v217
    v_cvt_pk_bf16_f32 v151, v216, v217
    s_nop 1
    s_branch L_rabK3
L_raS31:
    s_nop 7
    v_max_f32 v212, v212, v111
    v_max_f32 v213, v213, v119
    v_mov_b32 v214, v212
    v_mov_b32 v215, v213
    s_nop 1
    v_permlane32_swap_b32 v212, v214
    v_permlane32_swap_b32 v213, v215
    v_max_f32 v212, v212, v214
    v_max_f32 v213, v213, v215
    v_mov_b32 v214, v212
    v_mov_b32 v215, v213
    s_nop 1
    v_permlane16_swap_b32 v212, v214
    v_permlane16_swap_b32 v213, v215
    v_max_f32 v212, v212, v214
    v_max_f32 v213, v213, v215
    v_max_f32 v212, 0, v212
    v_ceil_f32 v212, v212
    v_sub_f32 v214, 0, v212
    v_exp_f32 v214, v214
    v_sub_f32 v192, v192, v212
    v_sub_f32 v193, v193, v212
    v_sub_f32 v194, v194, v212
    v_sub_f32 v195, v195, v212
    v_sub_f32 v104, v104, v212
    v_sub_f32 v105, v105, v212
    v_sub_f32 v106, v106, v212
    v_sub_f32 v107, v107, v212
    v_sub_f32 v108, v108, v212
    v_sub_f32 v109, v109, v212
    v_sub_f32 v110, v110, v212
    v_sub_f32 v111, v111, v212
    v_mul_f32 v152, v214, v152
    v_mul_f32 v153, v214, v153
    v_mul_f32 v154, v214, v154
    v_mul_f32 v155, v214, v155
    v_mul_f32 v160, v214, v160
    v_mul_f32 v161, v214, v161
    v_mul_f32 v162, v214, v162
    v_mul_f32 v163, v214, v163
    v_mul_f32 v168, v214, v168
    v_mul_f32 v169, v214, v169
    v_mul_f32 v170, v214, v170
    v_mul_f32 v171, v214, v171
    v_mul_f32 v176, v214, v176
    v_mul_f32 v177, v214, v177
    v_mul_f32 v178, v214, v178
    v_mul_f32 v179, v214, v179
    v_mul_f32 v184, v214, v184
    v_lshlrev_b32 v216, 16, v136
    v_and_b32 v217, 0xffff0000, v136
    v_mul_f32 v216, v214, v216
    v_mul_f32 v217, v214, v217
    v_cvt_pk_bf16_f32 v136, v216, v217
    v_lshlrev_b32 v216, 16, v137
    v_and_b32 v217, 0xffff0000, v137
    v_mul_f32 v216, v214, v216
    v_mul_f32 v217, v214, v217
    v_cvt_pk_bf16_f32 v137, v216, v217
    v_lshlrev_b32 v216, 16, v138
    v_and_b32 v217, 0xffff0000, v138
    v_mul_f32 v216, v214, v216
    v_mul_f32 v217, v214, v217
    v_cvt_pk_bf16_f32 v138, v216, v217
    v_lshlrev_b32 v216, 16, v139
    v_and_b32 v217, 0xffff0000, v139
    v_mul_f32 v216, v214, v216
    v_mul_f32 v217, v214, v217
    v_cvt_pk_bf16_f32 v139, v216, v217
    v_lshlrev_b32 v216, 16, v128
    v_and_b32 v217, 0xffff0000, v128
    v_mul_f32 v216, v214, v216
    v_mul_f32 v217, v214, v217
    v_cvt_pk_bf16_f32 v128, v216, v217
    v_lshlrev_b32 v216, 16, v129
    v_and_b32 v217, 0xffff0000, v129
    v_mul_f32 v216, v214, v216
    v_mul_f32 v217, v214, v217
    v_cvt_pk_bf16_f32 v129, v216, v217
    v_lshlrev_b32 v216, 16, v130
    v_and_b32 v217, 0xffff0000, v130
    v_mul_f32 v216, v214, v216
    v_mul_f32 v217, v214, v217
    v_cvt_pk_bf16_f32 v130, v216, v217
    v_lshlrev_b32 v216, 16, v131
    v_and_b32 v217, 0xffff0000, v131
    v_mul_f32 v216, v214, v216
    v_mul_f32 v217, v214, v217
    v_cvt_pk_bf16_f32 v131, v216, v217
    v_lshlrev_b32 v216, 16, v120
    v_and_b32 v217, 0xffff0000, v120
    v_mul_f32 v216, v214, v216
    v_mul_f32 v217, v214, v217
    v_cvt_pk_bf16_f32 v120, v216, v217
    v_lshlrev_b32 v216, 16, v121
    v_and_b32 v217, 0xffff0000, v121
    v_mul_f32 v216, v214, v216
    v_mul_f32 v217, v214, v217
    v_cvt_pk_bf16_f32 v121, v216, v217
    v_lshlrev_b32 v216, 16, v122
    v_and_b32 v217, 0xffff0000, v122
    v_mul_f32 v216, v214, v216
    v_mul_f32 v217, v214, v217
    v_cvt_pk_bf16_f32 v122, v216, v217
    v_lshlrev_b32 v216, 16, v123
    v_and_b32 v217, 0xffff0000, v123
    v_mul_f32 v216, v214, v216
    v_mul_f32 v217, v214, v217
    v_cvt_pk_bf16_f32 v123, v216, v217
    v_max_f32 v213, 0, v213
    v_ceil_f32 v213, v213
    v_sub_f32 v214, 0, v213
    v_exp_f32 v214, v214
    v_sub_f32 v196, v196, v213
    v_sub_f32 v197, v197, v213
    v_sub_f32 v198, v198, v213
    v_sub_f32 v199, v199, v213
    v_sub_f32 v112, v112, v213
    v_sub_f32 v113, v113, v213
    v_sub_f32 v114, v114, v213
    v_sub_f32 v115, v115, v213
    v_sub_f32 v116, v116, v213
    v_sub_f32 v117, v117, v213
    v_sub_f32 v118, v118, v213
    v_sub_f32 v119, v119, v213
    v_mul_f32 v156, v214, v156
    v_mul_f32 v157, v214, v157
    v_mul_f32 v158, v214, v158
    v_mul_f32 v159, v214, v159
    v_mul_f32 v164, v214, v164
    v_mul_f32 v165, v214, v165
    v_mul_f32 v166, v214, v166
    v_mul_f32 v167, v214, v167
    v_mul_f32 v172, v214, v172
    v_mul_f32 v173, v214, v173
    v_mul_f32 v174, v214, v174
    v_mul_f32 v175, v214, v175
    v_mul_f32 v180, v214, v180
    v_mul_f32 v181, v214, v181
    v_mul_f32 v182, v214, v182
    v_mul_f32 v183, v214, v183
    v_mul_f32 v188, v214, v188
    v_lshlrev_b32 v216, 16, v140
    v_and_b32 v217, 0xffff0000, v140
    v_mul_f32 v216, v214, v216
    v_mul_f32 v217, v214, v217
    v_cvt_pk_bf16_f32 v140, v216, v217
    v_lshlrev_b32 v216, 16, v141
    v_and_b32 v217, 0xffff0000, v141
    v_mul_f32 v216, v214, v216
    v_mul_f32 v217, v214, v217
    v_cvt_pk_bf16_f32 v141, v216, v217
    v_lshlrev_b32 v216, 16, v142
    v_and_b32 v217, 0xffff0000, v142
    v_mul_f32 v216, v214, v216
    v_mul_f32 v217, v214, v217
    v_cvt_pk_bf16_f32 v142, v216, v217
    v_lshlrev_b32 v216, 16, v143
    v_and_b32 v217, 0xffff0000, v143
    v_mul_f32 v216, v214, v216
    v_mul_f32 v217, v214, v217
    v_cvt_pk_bf16_f32 v143, v216, v217
    v_lshlrev_b32 v216, 16, v132
    v_and_b32 v217, 0xffff0000, v132
    v_mul_f32 v216, v214, v216
    v_mul_f32 v217, v214, v217
    v_cvt_pk_bf16_f32 v132, v216, v217
    v_lshlrev_b32 v216, 16, v133
    v_and_b32 v217, 0xffff0000, v133
    v_mul_f32 v216, v214, v216
    v_mul_f32 v217, v214, v217
    v_cvt_pk_bf16_f32 v133, v216, v217
    v_lshlrev_b32 v216, 16, v134
    v_and_b32 v217, 0xffff0000, v134
    v_mul_f32 v216, v214, v216
    v_mul_f32 v217, v214, v217
    v_cvt_pk_bf16_f32 v134, v216, v217
    v_lshlrev_b32 v216, 16, v135
    v_and_b32 v217, 0xffff0000, v135
    v_mul_f32 v216, v214, v216
    v_mul_f32 v217, v214, v217
    v_cvt_pk_bf16_f32 v135, v216, v217
    v_lshlrev_b32 v216, 16, v124
    v_and_b32 v217, 0xffff0000, v124
    v_mul_f32 v216, v214, v216
    v_mul_f32 v217, v214, v217
    v_cvt_pk_bf16_f32 v124, v216, v217
    v_lshlrev_b32 v216, 16, v125
    v_and_b32 v217, 0xffff0000, v125
    v_mul_f32 v216, v214, v216
    v_mul_f32 v217, v214, v217
    v_cvt_pk_bf16_f32 v125, v216, v217
    v_lshlrev_b32 v216, 16, v126
    v_and_b32 v217, 0xffff0000, v126
    v_mul_f32 v216, v214, v216
    v_mul_f32 v217, v214, v217
    v_cvt_pk_bf16_f32 v126, v216, v217
    v_lshlrev_b32 v216, 16, v127
    v_and_b32 v217, 0xffff0000, v127
    v_mul_f32 v216, v214, v216
    v_mul_f32 v217, v214, v217
    v_cvt_pk_bf16_f32 v127, v216, v217
    s_nop 1
    s_branch L_rabS31
.section .rodata,"a"
.p2align 6
.amdhsa_kernel standalone__gqa_softmax__sampling_kernel
  .amdhsa_next_free_vgpr 222
  .amdhsa_next_free_sgpr 72
  .amdhsa_accum_offset 224
  .amdhsa_group_segment_fixed_size 0
  .amdhsa_kernarg_size 48
  .amdhsa_user_sgpr_count 2
  .amdhsa_user_sgpr_kernarg_segment_ptr 1
  .amdhsa_system_sgpr_workgroup_id_x 1
.end_amdhsa_kernel
```
